```python
import torch

def _softmax(x, axis=-1):
    return torch.softmax(x, dim=axis)
def _gelu(x):
    return torch.nn.functional.gelu(x, approximate="tanh")
def _silu(x):
    return torch.nn.functional.silu(x)
def _sigmoid(x):
    return torch.sigmoid(x)
def _layernorm(x, axis=-1, eps=1e-5):
    m = x.mean(dim=axis, keepdim=True)
    v = x.var(dim=axis, keepdim=True, unbiased=False)
    return (x - m) / torch.sqrt(v + eps)
def _scatter_add(tgt, idx, src, axis=0):
    return tgt.clone().index_add_(axis, idx, src)
def _segment_sum(src, seg, n):
    out = torch.zeros((n,) + src.shape[1:], dtype=src.dtype)
    return out.index_add_(0, seg, src)
def _pad(x, pw):
    flat = tuple(v for pair in reversed(pw) for v in pair)
    return torch.nn.functional.pad(x, flat)

kernel_name = 'gated_mix__mha_block__linear_attn_block__prompt'

def setup_inputs():

    _w = (lambda a: (lambda t: t.to(torch.bfloat16) if t.is_floating_point() else t)(torch.as_tensor(a)))
    def _A_setup():
        B, S, D, H = 1, 2048, 448, 16
        return {
            "x": _w((lambda *s: torch.randn(*s, dtype=torch.bfloat16) * 0.05)(B, S, D)),
            "wqkv": _w((lambda *s: torch.randn(*s, dtype=torch.bfloat16) * 0.8)(D, 3 * D)),
            "wo": _w((lambda *s: torch.randn(*s, dtype=torch.bfloat16) * 0.05)(D, D)),
        }
    _A_in = _A_setup()

    def _B_setup():
        B, S, D = 1, 2048, 448
        return {
            "x": _w((lambda *s: torch.randn(*s, dtype=torch.bfloat16) * 0.05)(B, S, D)),
            "wqkv": _w((lambda *s: torch.randn(*s, dtype=torch.bfloat16) * 0.8)(D, 3 * D)),
            "wo": _w((lambda *s: torch.randn(*s, dtype=torch.bfloat16) * 0.1)(D, D)),
        }
    _B_in = _B_setup()

    return {
        "A_x": _A_in["x"],
        "A_wqkv": _A_in["wqkv"],
        "A_wo": _A_in["wo"],
        "B_x": _B_in["x"],
        "B_wqkv": _B_in["wqkv"],
        "B_wo": _B_in["wo"],
        "gate_w": _w((lambda *s: torch.randn(*s, dtype=torch.bfloat16) * 0.05)(448) * 16.0),
    }

def reference(A_x, A_wqkv, A_wo, B_x, B_wqkv, B_wo, gate_w):
    def _A_ref(x, wqkv, wo):
        B, S, D = x.shape
        H = 16
        Dh = D // H
        qkv = (lambda x, *d: x.permute(*d))((x @ wqkv).reshape(B, S, 3, H, Dh), 2, 0, 3, 1, 4)
        q, k, v = qkv[0], qkv[1], qkv[2]
        scores = torch.einsum("bhqd,bhkd->bhqk", q, k) * (Dh ** -0.5)
        p = _softmax(scores, axis=-1)
        o = torch.einsum("bhqk,bhkd->bhqd", p, v)
        return (lambda x, *d: x.permute(*d))(o, 0, 2, 1, 3).reshape(B, S, D) @ wo

    def _B_ref(x, wqkv, wo):
        B, S, D = x.shape
        H = 16; Dh = D // H
        qkv = (lambda x, *d: x.permute(*d))((x @ wqkv).reshape(B, S, 3, H, Dh), 2, 0, 3, 1, 4)
        q, k, v = qkv[0], qkv[1], qkv[2]
        phi = lambda t: torch.where(t > 0, t + 1, torch.exp(t)) + 1e-6
        pq, pk = phi(q), phi(k)
        kv = torch.einsum("bhsd,bhse->bhde", pk, v)
        z = torch.einsum("bhsd->bhd", pk)
        num = torch.einsum("bhqd,bhde->bhqe", pq, kv)
        den = torch.einsum("bhqd,bhd->bhq", pq, z)[..., None] + 1e-6
        o = num / den
        return (lambda x, *d: x.permute(*d))(o, 0, 2, 1, 3).reshape(B, S, D) @ wo

    x = A_x
    g = _sigmoid((x * gate_w).sum(-1, keepdims=True))
    a = _A_ref(x, A_wqkv, A_wo)
    b = _B_ref(x, B_wqkv, B_wo)
    return g * a + (1 - g) * b
```

```asm
; @launch grid=(256,1,1) block=(512,1,1) lds=163840
.amdgcn_target "amdgcn-amd-amdhsa--gfx950"
.text
.globl gated_mix__mha_block__linear_attn_block__prompt_kernel
.p2align 8
.type gated_mix__mha_block__linear_attn_block__prompt_kernel,@function
gated_mix__mha_block__linear_attn_block__prompt_kernel:
    s_cmp_ge_u32 s2, 256
    s_cbranch_scc1 L_end
    s_load_dwordx16 s[40:55], s[0:1], 0
    s_load_dwordx4 s[56:59], s[0:1], 64
    s_getpc_b64 s[36:37]
L_pc:
    v_lshrrev_b32 v2, 6, v0
    v_and_b32 v1, 63, v0
    s_and_b32 s75, s2, 0x38
    v_readfirstlane_b32 s83, v2
    v_add_u32 v3, s75, v2
    v_lshl_add_u32 v3, v3, 3, v1
    v_lshlrev_b32 v3, 7, v3
    s_mov_b32 s75, L_codeend-L_pc-4
    v_min_u32 v3, s75, v3
    s_mov_b64 exec, 0xff
    global_load_dword v18, v3, s[36:37]
    s_mov_b64 exec, -1
    s_and_b32 s3, s83, 3
    s_lshr_b32 s74, s2, 3
    s_and_b32 s75, s2, 1
    s_lshl_b32 s75, s75, 3
    s_and_b32 s76, s74, 7
    s_add_u32 s61, s75, s76
    s_and_b32 s75, s2, 6
    s_lshl_b32 s75, s75, 1
    s_lshr_b32 s76, s2, 6
    s_add_u32 s62, s75, s76
    v_lshlrev_b32 v0, 4, v1
    s_cmp_ge_u32 s83, 4
    s_cbranch_scc1 L_helper
    v_lshl_add_u32 v3, s2, 2, v2
    v_mad_u32_u24 v4, v3, 14, v1
    v_mad_u32_u24 v5, v3, 10, v1
    v_lshlrev_b32 v4, 7, v4
    v_min_u32 v5, 9407, v5
    v_lshlrev_b32 v5, 7, v5
    s_mov_b64 exec, 0x3fff
    s_waitcnt lgkmcnt(0)
    global_load_dword v18, v4, s[40:41]
    s_mov_b64 exec, 0x3ff
    global_load_dword v18, v5, s[42:43]
    global_load_dword v18, v5, s[48:49]
    s_mov_b64 exec, -1
    s_branch L_main
L_helper:
    v_lshrrev_b32 v10, 3, v1
    v_and_b32 v11, 7, v1
    v_lshrrev_b32 v12, 4, v1
    v_xor_b32 v2, v11, v12
    v_lshlrev_b32 v2, 4, v2
    s_lshl_b32 s75, s61, 2
    s_add_u32 s75, s75, s3
    s_mul_i32 s75, s75, 28672
    v_mul_u32_u24 v13, 896, v10
    v_add3_u32 v3, s75, v13, v2
    v_xor_b32 v4, 64, v3
    v_add_u32 v4, 6144, v4
    v_add_u32 v5, 12288, v3
    v_add_u32 v6, 12288, v4
    s_lshl_b32 s81, s3, 12
    s_lshl_b32 s82, s3, 11
    s_mov_b32 s6, 1835008
    s_mov_b32 s7, 0x20000
    v_and_b32 v9, 1, v12
    v_lshlrev_b32 v9, 2, v9
    v_xor_b32 v9, v9, v11
    v_lshlrev_b32 v9, 4, v9
    s_mul_i32 s76, s3, 43008
    v_mul_u32_u24 v14, 2688, v10
    v_add3_u32 v7, s76, v14, v9
    v_add_u32 v8, 20480, v7
    s_cmp_ge_u32 s62, 14
    s_waitcnt lgkmcnt(0)
    s_mov_b32 s4, s40
    s_mov_b32 s5, s41
    s_cbranch_scc1 L_h_gate
    s_add_u32 m0, s81, 0
    s_mov_b32 s73, 0
    buffer_load_dwordx4 v3, s[4:7], s73 offen offset:0 lds
    buffer_load_dwordx4 v4, s[4:7], s73 offen offset:1024 lds
    buffer_load_dwordx4 v5, s[4:7], s73 offen offset:2048 lds
    buffer_load_dwordx4 v6, s[4:7], s73 offen offset:3072 lds
    s_lshl_b32 s75, s62, 1
    s_add_u32 s75, s75, 0
    s_sub_u32 s76, s75, 7
    s_cmp_lt_u32 s75, 21
    s_cselect_b32 s75, s75, s76
    s_cselect_b32 s8, s42, s48
    s_cselect_b32 s9, s43, s49
    s_lshl_b32 s75, s75, 7
    s_add_u32 s8, s8, s75
    s_addc_u32 s9, s9, 0
    s_sub_u32 s10, 1204224, s75
    s_mov_b32 s11, 0x20000
    s_add_u32 m0, s82, 16384
    s_mov_b32 s73, 0
    buffer_load_dwordx4 v7, s[8:11], s73 offen offset:0 lds
    buffer_load_dwordx4 v8, s[8:11], s73 offen offset:1024 lds
    s_lshl_b32 s75, s62, 1
    s_add_u32 s75, s75, 1
    s_sub_u32 s76, s75, 7
    s_cmp_lt_u32 s75, 21
    s_cselect_b32 s75, s75, s76
    s_cselect_b32 s12, s42, s48
    s_cselect_b32 s13, s43, s49
    s_lshl_b32 s75, s75, 7
    s_add_u32 s12, s12, s75
    s_addc_u32 s13, s13, 0
    s_sub_u32 s14, 1204224, s75
    s_mov_b32 s15, 0x20000
    s_add_u32 m0, s82, 24576
    s_mov_b32 s73, 0
    buffer_load_dwordx4 v7, s[12:15], s73 offen offset:0 lds
    buffer_load_dwordx4 v8, s[12:15], s73 offen offset:1024 lds
    s_add_u32 m0, s81, 32768
    s_mov_b32 s73, 128
    buffer_load_dwordx4 v3, s[4:7], s73 offen offset:0 lds
    buffer_load_dwordx4 v4, s[4:7], s73 offen offset:1024 lds
    buffer_load_dwordx4 v5, s[4:7], s73 offen offset:2048 lds
    buffer_load_dwordx4 v6, s[4:7], s73 offen offset:3072 lds
    s_add_u32 m0, s82, 49152
    s_mov_b32 s73, 172032
    buffer_load_dwordx4 v7, s[8:11], s73 offen offset:0 lds
    buffer_load_dwordx4 v8, s[8:11], s73 offen offset:1024 lds
    s_add_u32 m0, s82, 57344
    s_mov_b32 s73, 172032
    buffer_load_dwordx4 v7, s[12:15], s73 offen offset:0 lds
    buffer_load_dwordx4 v8, s[12:15], s73 offen offset:1024 lds
    s_setprio 1
    s_mov_b32 s73, 16711680
    s_load_dword s60, s[58:59], s73
    s_and_b32 s73, s2, 7
    s_lshr_b32 s74, s2, 3
    s_and_b32 s66, s74, 1
    s_lshl_b32 s75, s73, 1
    s_add_u32 s63, s75, s66
    s_lshr_b32 s64, s74, 1
    s_mul_i32 s75, s63, 7
    s_lshr_b32 s65, s75, 1
    s_mul_i32 s75, s74, 37
    s_lshr_b32 s75, s75, 8
    s_mul_i32 s76, s75, 7
    s_sub_u32 s68, s74, s76
    s_lshl_b32 s76, s73, 2
    s_add_u32 s67, s76, s75
    s_cmp_lt_u32 s74, 28
    s_cselect_b32 s69, 1, 0
    s_cselect_b32 s67, s67, 0
    s_mul_i32 s75, s63, 28
    s_lshr_b32 s70, s75, 6
    s_add_u32 s75, s75, 27
    s_lshr_b32 s71, s75, 6
    s_mov_b32 s79, 262144
    s_mov_b32 s80, 0
    s_lshl_b32 s75, s62, 4
    s_add_u32 s75, s75, s61
    s_lshl_b32 s97, s75, 7
    s_lshl_b32 s75, s63, 4
    s_add_u32 s75, s75, s64
    s_lshl_b32 s96, s75, 7
    v_cmp_eq_u32 s[90:91], 0, v1
    v_mov_b32 v27, 0
    v_mov_b32 v17, 155648
    v_mov_b32 v16, 1
    s_lshl_b32 s77, s68, 7
    v_add3_u32 v26, s77, v13, v9
    s_lshl_b32 s75, s62, 7
    s_add_u32 s16, s48, s75
    s_addc_u32 s17, s49, 0
    s_sub_u32 s18, 1204224, s75
    s_mov_b32 s19, 0x20000
    s_mov_b32 s20, s58
    s_mov_b32 s21, s59
    s_mov_b32 s22, 17825792
    s_mov_b32 s23, 0x20000
    s_mov_b32 s24, s54
    s_mov_b32 s25, s55
    s_mov_b32 s26, 1835008
    s_mov_b32 s27, 0x20000
    s_mov_b32 s28, s44
    s_mov_b32 s29, s45
    s_mov_b32 s30, 401408
    s_mov_b32 s31, 0x20000
    s_mov_b32 s32, s50
    s_mov_b32 s33, s51
    s_mov_b32 s34, 401408
    s_mov_b32 s35, 0x20000
    s_cmp_ge_u32 s62, 7
    s_cbranch_scc1 L_h_N
    v_and_b32 v10, 31, v1
    v_mov_b32 v11, v10
    v_lshrrev_b32 v12, 5, v1
    v_lshrrev_b32 v13, 1, v11
    v_and_b32 v13, 7, v13
    v_lshlrev_b32 v11, 7, v11
    v_add_u32 v11, s81, v11
    v_add_u32 v10, 0, v12
    v_xor_b32 v10, v10, v13
    v_lshl_add_u32 v96, v10, 4, v11
    v_add_u32 v100, 65536, v96
    v_add_u32 v10, 2, v12
    v_xor_b32 v10, v10, v13
    v_lshl_add_u32 v97, v10, 4, v11
    v_add_u32 v101, 65536, v97
    v_add_u32 v10, 4, v12
    v_xor_b32 v10, v10, v13
    v_lshl_add_u32 v98, v10, 4, v11
    v_add_u32 v102, 65536, v98
    v_add_u32 v10, 6, v12
    v_xor_b32 v10, v10, v13
    v_lshl_add_u32 v99, v10, 4, v11
    v_add_u32 v103, 65536, v99
    v_and_b32 v10, 3, v1
    v_and_b32 v11, 1, v10
    v_lshrrev_b32 v10, 1, v10
    v_lshl_or_b32 v10, v11, 1, v10
    v_bfe_u32 v11, v1, 4, 1
    v_lshl_or_b32 v10, v11, 2, v10
    v_bfe_u32 v11, v1, 2, 2
    v_lshrrev_b32 v12, 5, v1
    v_lshl_add_u32 v11, v12, 3, v11
    v_lshlrev_b32 v11, 7, v11
    v_lshl_add_u32 v11, v10, 3, v11
    v_bfe_u32 v10, v1, 3, 1
    v_lshl_or_b32 v13, v10, 6, v11
    v_add_u32 v108, 98304, v13
    v_xor_b32 v109, 64, v108
    s_lshl_b32 s75, s61, 2
    s_add_u32 s75, s75, s3
    s_mul_i32 s77, s75, 86016
    s_add_u32 s78, s62, 14
    s_lshl_b32 s78, s78, 12
    s_add_u32 s78, s78, s77
    v_add_u32 v110, s78, v0
    v_add_u32 v111, 2048, v110
    s_waitcnt vmcnt(8)
    s_barrier
    ds_read_b128 v[144:147], v96 offset:0
    ds_read_b128 v[148:151], v97 offset:0
    ds_read_b128 v[152:155], v98 offset:0
    ds_read_b128 v[156:159], v99 offset:0
    s_add_u32 m0, s81, 65536
    s_mov_b32 s73, 256
    buffer_load_dwordx4 v3, s[4:7], s73 offen offset:0 lds
    buffer_load_dwordx4 v4, s[4:7], s73 offen offset:1024 lds
    buffer_load_dwordx4 v5, s[4:7], s73 offen offset:2048 lds
    buffer_load_dwordx4 v6, s[4:7], s73 offen offset:3072 lds
    s_add_u32 m0, s82, 81920
    s_mov_b32 s73, 344064
    buffer_load_dwordx4 v7, s[8:11], s73 offen offset:0 lds
    buffer_load_dwordx4 v8, s[8:11], s73 offen offset:1024 lds
    s_add_u32 m0, s82, 90112
    s_mov_b32 s73, 344064
    buffer_load_dwordx4 v7, s[12:15], s73 offen offset:0 lds
    buffer_load_dwordx4 v8, s[12:15], s73 offen offset:1024 lds
    s_add_u32 m0, s81, 98304
    s_mov_b32 s73, 384
    buffer_load_dwordx4 v3, s[4:7], s73 offen offset:0 lds
    buffer_load_dwordx4 v4, s[4:7], s73 offen offset:1024 lds
    buffer_load_dwordx4 v5, s[4:7], s73 offen offset:2048 lds
    buffer_load_dwordx4 v6, s[4:7], s73 offen offset:3072 lds
    s_add_u32 m0, s82, 114688
    s_mov_b32 s73, 516096
    buffer_load_dwordx4 v7, s[8:11], s73 offen offset:0 lds
    buffer_load_dwordx4 v8, s[8:11], s73 offen offset:1024 lds
    s_add_u32 m0, s82, 122880
    s_mov_b32 s73, 516096
    buffer_load_dwordx4 v7, s[12:15], s73 offen offset:0 lds
    buffer_load_dwordx4 v8, s[12:15], s73 offen offset:1024 lds
    s_waitcnt vmcnt(16)
    s_waitcnt lgkmcnt(0)
    s_barrier
    ds_read_b128 v[160:163], v96 offset:32768
    ds_read_b128 v[164:167], v97 offset:32768
    ds_read_b128 v[168:171], v98 offset:32768
    ds_read_b128 v[172:175], v99 offset:32768
    s_add_u32 m0, s81, 0
    s_mov_b32 s73, 512
    buffer_load_dwordx4 v3, s[4:7], s73 offen offset:0 lds
    buffer_load_dwordx4 v4, s[4:7], s73 offen offset:1024 lds
    buffer_load_dwordx4 v5, s[4:7], s73 offen offset:2048 lds
    buffer_load_dwordx4 v6, s[4:7], s73 offen offset:3072 lds
    s_add_u32 m0, s82, 16384
    s_mov_b32 s73, 688128
    buffer_load_dwordx4 v7, s[8:11], s73 offen offset:0 lds
    buffer_load_dwordx4 v8, s[8:11], s73 offen offset:1024 lds
    s_add_u32 m0, s82, 24576
    s_mov_b32 s73, 688128
    buffer_load_dwordx4 v7, s[12:15], s73 offen offset:0 lds
    buffer_load_dwordx4 v8, s[12:15], s73 offen offset:1024 lds
    s_waitcnt vmcnt(16)
    s_waitcnt lgkmcnt(0)
    s_barrier
    ds_read_b128 v[176:179], v100 offset:0
    ds_read_b128 v[180:183], v101 offset:0
    ds_read_b128 v[184:187], v102 offset:0
    ds_read_b128 v[188:191], v103 offset:0
    s_add_u32 m0, s81, 32768
    s_mov_b32 s73, 640
    buffer_load_dwordx4 v3, s[4:7], s73 offen offset:0 lds
    buffer_load_dwordx4 v4, s[4:7], s73 offen offset:1024 lds
    buffer_load_dwordx4 v5, s[4:7], s73 offen offset:2048 lds
    buffer_load_dwordx4 v6, s[4:7], s73 offen offset:3072 lds
    s_add_u32 m0, s82, 49152
    s_mov_b32 s73, 860160
    buffer_load_dwordx4 v7, s[8:11], s73 offen offset:0 lds
    buffer_load_dwordx4 v8, s[8:11], s73 offen offset:1024 lds
    s_add_u32 m0, s82, 57344
    s_mov_b32 s73, 860160
    buffer_load_dwordx4 v7, s[12:15], s73 offen offset:0 lds
    buffer_load_dwordx4 v8, s[12:15], s73 offen offset:1024 lds
    s_waitcnt vmcnt(16)
    s_waitcnt lgkmcnt(0)
    s_barrier
    ds_read_b128 v[192:195], v100 offset:32768
    ds_read_b128 v[196:199], v101 offset:32768
    ds_read_b128 v[200:203], v102 offset:32768
    ds_read_b128 v[204:207], v103 offset:32768
    s_add_u32 m0, s81, 65536
    s_mov_b32 s73, 768
    buffer_load_dwordx4 v3, s[4:7], s73 offen offset:0 lds
    buffer_load_dwordx4 v4, s[4:7], s73 offen offset:1024 lds
    buffer_load_dwordx4 v5, s[4:7], s73 offen offset:2048 lds
    buffer_load_dwordx4 v6, s[4:7], s73 offen offset:3072 lds
    s_add_u32 m0, s82, 81920
    s_mov_b32 s73, 1032192
    buffer_load_dwordx4 v7, s[8:11], s73 offen offset:0 lds
    buffer_load_dwordx4 v8, s[8:11], s73 offen offset:1024 lds
    s_add_u32 m0, s82, 90112
    s_mov_b32 s73, 1032192
    buffer_load_dwordx4 v7, s[12:15], s73 offen offset:0 lds
    buffer_load_dwordx4 v8, s[12:15], s73 offen offset:1024 lds
    s_waitcnt vmcnt(16)
    s_waitcnt lgkmcnt(0)
    s_barrier
    ds_read_b128 v[208:211], v96 offset:0
    ds_read_b128 v[212:215], v97 offset:0
    ds_read_b128 v[216:219], v98 offset:0
    ds_read_b128 v[220:223], v99 offset:0
    s_add_u32 m0, s82, 98304
    s_mov_b32 s73, 0
    buffer_load_dwordx4 v7, s[16:19], s73 offen offset:0 lds
    buffer_load_dwordx4 v8, s[16:19], s73 offen offset:1024 lds
    s_add_u32 m0, s82, 106496
    s_mov_b32 s73, 172032
    buffer_load_dwordx4 v7, s[16:19], s73 offen offset:0 lds
    buffer_load_dwordx4 v8, s[16:19], s73 offen offset:1024 lds
    s_add_u32 m0, s82, 114688
    s_mov_b32 s73, 344064
    buffer_load_dwordx4 v7, s[16:19], s73 offen offset:0 lds
    buffer_load_dwordx4 v8, s[16:19], s73 offen offset:1024 lds
    s_add_u32 m0, s82, 122880
    s_mov_b32 s73, 516096
    buffer_load_dwordx4 v7, s[16:19], s73 offen offset:0 lds
    buffer_load_dwordx4 v8, s[16:19], s73 offen offset:1024 lds
    s_waitcnt vmcnt(16)
    s_waitcnt lgkmcnt(0)
    s_barrier
    ds_read_b128 v[224:227], v96 offset:32768
    ds_read_b128 v[228:231], v97 offset:32768
    ds_read_b128 v[232:235], v98 offset:32768
    ds_read_b128 v[236:239], v99 offset:32768
    s_add_u32 m0, s82, 131072
    s_mov_b32 s73, 688128
    buffer_load_dwordx4 v7, s[16:19], s73 offen offset:0 lds
    buffer_load_dwordx4 v8, s[16:19], s73 offen offset:1024 lds
    s_add_u32 m0, s82, 139264
    s_mov_b32 s73, 860160
    buffer_load_dwordx4 v7, s[16:19], s73 offen offset:0 lds
    buffer_load_dwordx4 v8, s[16:19], s73 offen offset:1024 lds
    s_add_u32 m0, s82, 147456
    s_mov_b32 s73, 1032192
    buffer_load_dwordx4 v7, s[16:19], s73 offen offset:0 lds
    buffer_load_dwordx4 v8, s[16:19], s73 offen offset:1024 lds
    s_waitcnt vmcnt(14)
    s_waitcnt lgkmcnt(0)
    s_barrier
    ds_read_b128 v[240:243], v100 offset:0
    ds_read_b128 v[244:247], v101 offset:0
    ds_read_b128 v[248:251], v102 offset:0
    ds_read_b128 v[252:255], v103 offset:0
    s_waitcnt vmcnt(0)
    s_waitcnt lgkmcnt(0)
    s_add_u32 s60, s60, 0x9e3779b1
    v_mov_b32 v30, s60
    s_mov_b64 exec, 1
    ds_add_u32 v17, v16 offset:4
    s_mov_b64 exec, -1
L_spin_1:
    ds_read_b32 v2, v17 offset:4
    s_waitcnt lgkmcnt(0)
    v_readfirstlane_b32 s83, v2
    s_cmp_ge_u32 s83, 4
    s_cbranch_scc1 L_spun_2
    s_sub_u32 s79, s79, 1
    s_cbranch_scc0 L_spin_1
    s_mov_b32 s79, 0
L_spun_2:
    ds_read_b64_tr_b16 v[32:33], v108 offset:0
    ds_read_b64_tr_b16 v[34:35], v108 offset:512
    ds_read_b64_tr_b16 v[36:37], v109 offset:0
    ds_read_b64_tr_b16 v[38:39], v109 offset:512
    ds_read_b64_tr_b16 v[40:41], v108 offset:2048
    ds_read_b64_tr_b16 v[42:43], v108 offset:2560
    ds_read_b64_tr_b16 v[44:45], v109 offset:2048
    ds_read_b64_tr_b16 v[46:47], v109 offset:2560
    s_mul_i32 s75, s3, 14336
    s_mul_i32 s76, s3, 100352
    s_waitcnt lgkmcnt(4)
    v_mfma_f32_32x32x16_bf16 v[64:79], v[32:35], v[144:147], 0
    ds_read_b64_tr_b16 v[48:49], v108 offset:4096
    ds_read_b64_tr_b16 v[50:51], v108 offset:4608
    ds_read_b64_tr_b16 v[52:53], v109 offset:4096
    ds_read_b64_tr_b16 v[54:55], v109 offset:4608
    v_mfma_f32_32x32x16_bf16 v[80:95], v[36:39], v[144:147], 0
    s_waitcnt lgkmcnt(4)
    v_mfma_f32_32x32x16_bf16 v[64:79], v[40:43], v[148:151], v[64:79]
    ds_read_b64_tr_b16 v[56:57], v108 offset:6144
    ds_read_b64_tr_b16 v[58:59], v108 offset:6656
    ds_read_b64_tr_b16 v[60:61], v109 offset:6144
    ds_read_b64_tr_b16 v[62:63], v109 offset:6656
    v_mfma_f32_32x32x16_bf16 v[80:95], v[44:47], v[148:151], v[80:95]
    s_waitcnt lgkmcnt(4)
    v_mfma_f32_32x32x16_bf16 v[64:79], v[48:51], v[152:155], v[64:79]
    ds_read_b64_tr_b16 v[32:33], v108 offset:8192
    ds_read_b64_tr_b16 v[34:35], v108 offset:8704
    ds_read_b64_tr_b16 v[36:37], v109 offset:8192
    ds_read_b64_tr_b16 v[38:39], v109 offset:8704
    v_mfma_f32_32x32x16_bf16 v[80:95], v[52:55], v[152:155], v[80:95]
    s_waitcnt lgkmcnt(4)
    v_mfma_f32_32x32x16_bf16 v[64:79], v[56:59], v[156:159], v[64:79]
    ds_read_b64_tr_b16 v[40:41], v108 offset:10240
    ds_read_b64_tr_b16 v[42:43], v108 offset:10752
    ds_read_b64_tr_b16 v[44:45], v109 offset:10240
    ds_read_b64_tr_b16 v[46:47], v109 offset:10752
    v_mfma_f32_32x32x16_bf16 v[80:95], v[60:63], v[156:159], v[80:95]
    s_waitcnt lgkmcnt(4)
    v_mfma_f32_32x32x16_bf16 v[64:79], v[32:35], v[160:163], v[64:79]
    ds_read_b64_tr_b16 v[48:49], v108 offset:12288
    ds_read_b64_tr_b16 v[50:51], v108 offset:12800
    ds_read_b64_tr_b16 v[52:53], v109 offset:12288
    ds_read_b64_tr_b16 v[54:55], v109 offset:12800
    v_mfma_f32_32x32x16_bf16 v[80:95], v[36:39], v[160:163], v[80:95]
    s_waitcnt lgkmcnt(4)
    v_mfma_f32_32x32x16_bf16 v[64:79], v[40:43], v[164:167], v[64:79]
    ds_read_b64_tr_b16 v[56:57], v108 offset:14336
    ds_read_b64_tr_b16 v[58:59], v108 offset:14848
    ds_read_b64_tr_b16 v[60:61], v109 offset:14336
    ds_read_b64_tr_b16 v[62:63], v109 offset:14848
    v_mfma_f32_32x32x16_bf16 v[80:95], v[44:47], v[164:167], v[80:95]
    s_waitcnt lgkmcnt(4)
    v_mfma_f32_32x32x16_bf16 v[64:79], v[48:51], v[168:171], v[64:79]
    ds_read_b64_tr_b16 v[32:33], v108 offset:16384
    ds_read_b64_tr_b16 v[34:35], v108 offset:16896
    ds_read_b64_tr_b16 v[36:37], v109 offset:16384
    ds_read_b64_tr_b16 v[38:39], v109 offset:16896
    v_mfma_f32_32x32x16_bf16 v[80:95], v[52:55], v[168:171], v[80:95]
    s_waitcnt lgkmcnt(4)
    v_mfma_f32_32x32x16_bf16 v[64:79], v[56:59], v[172:175], v[64:79]
    ds_read_b64_tr_b16 v[40:41], v108 offset:18432
    ds_read_b64_tr_b16 v[42:43], v108 offset:18944
    ds_read_b64_tr_b16 v[44:45], v109 offset:18432
    ds_read_b64_tr_b16 v[46:47], v109 offset:18944
    v_mfma_f32_32x32x16_bf16 v[80:95], v[60:63], v[172:175], v[80:95]
    s_waitcnt lgkmcnt(4)
    v_mfma_f32_32x32x16_bf16 v[64:79], v[32:35], v[176:179], v[64:79]
    ds_read_b64_tr_b16 v[48:49], v108 offset:20480
    ds_read_b64_tr_b16 v[50:51], v108 offset:20992
    ds_read_b64_tr_b16 v[52:53], v109 offset:20480
    ds_read_b64_tr_b16 v[54:55], v109 offset:20992
    v_mfma_f32_32x32x16_bf16 v[80:95], v[36:39], v[176:179], v[80:95]
    s_waitcnt lgkmcnt(4)
    v_mfma_f32_32x32x16_bf16 v[64:79], v[40:43], v[180:183], v[64:79]
    ds_read_b64_tr_b16 v[56:57], v108 offset:22528
    ds_read_b64_tr_b16 v[58:59], v108 offset:23040
    ds_read_b64_tr_b16 v[60:61], v109 offset:22528
    ds_read_b64_tr_b16 v[62:63], v109 offset:23040
    v_mfma_f32_32x32x16_bf16 v[80:95], v[44:47], v[180:183], v[80:95]
    s_waitcnt lgkmcnt(4)
    v_mfma_f32_32x32x16_bf16 v[64:79], v[48:51], v[184:187], v[64:79]
    ds_read_b64_tr_b16 v[32:33], v108 offset:24576
    ds_read_b64_tr_b16 v[34:35], v108 offset:25088
    ds_read_b64_tr_b16 v[36:37], v109 offset:24576
    ds_read_b64_tr_b16 v[38:39], v109 offset:25088
    v_mfma_f32_32x32x16_bf16 v[80:95], v[52:55], v[184:187], v[80:95]
    s_waitcnt lgkmcnt(4)
    v_mfma_f32_32x32x16_bf16 v[64:79], v[56:59], v[188:191], v[64:79]
    ds_read_b64_tr_b16 v[40:41], v108 offset:26624
    ds_read_b64_tr_b16 v[42:43], v108 offset:27136
    ds_read_b64_tr_b16 v[44:45], v109 offset:26624
    ds_read_b64_tr_b16 v[46:47], v109 offset:27136
    v_mfma_f32_32x32x16_bf16 v[80:95], v[60:63], v[188:191], v[80:95]
    s_waitcnt lgkmcnt(4)
    v_mfma_f32_32x32x16_bf16 v[64:79], v[32:35], v[192:195], v[64:79]
    ds_read_b64_tr_b16 v[48:49], v108 offset:28672
    ds_read_b64_tr_b16 v[50:51], v108 offset:29184
    ds_read_b64_tr_b16 v[52:53], v109 offset:28672
    ds_read_b64_tr_b16 v[54:55], v109 offset:29184
    v_mfma_f32_32x32x16_bf16 v[80:95], v[36:39], v[192:195], v[80:95]
    s_waitcnt lgkmcnt(4)
    v_mfma_f32_32x32x16_bf16 v[64:79], v[40:43], v[196:199], v[64:79]
    ds_read_b64_tr_b16 v[56:57], v108 offset:30720
    ds_read_b64_tr_b16 v[58:59], v108 offset:31232
    ds_read_b64_tr_b16 v[60:61], v109 offset:30720
    ds_read_b64_tr_b16 v[62:63], v109 offset:31232
    v_mfma_f32_32x32x16_bf16 v[80:95], v[44:47], v[196:199], v[80:95]
    s_waitcnt lgkmcnt(4)
    v_mfma_f32_32x32x16_bf16 v[64:79], v[48:51], v[200:203], v[64:79]
    ds_read_b64_tr_b16 v[32:33], v108 offset:32768
    ds_read_b64_tr_b16 v[34:35], v108 offset:33280
    ds_read_b64_tr_b16 v[36:37], v109 offset:32768
    ds_read_b64_tr_b16 v[38:39], v109 offset:33280
    v_mfma_f32_32x32x16_bf16 v[80:95], v[52:55], v[200:203], v[80:95]
    s_waitcnt lgkmcnt(4)
    v_mfma_f32_32x32x16_bf16 v[64:79], v[56:59], v[204:207], v[64:79]
    ds_read_b64_tr_b16 v[40:41], v108 offset:34816
    ds_read_b64_tr_b16 v[42:43], v108 offset:35328
    ds_read_b64_tr_b16 v[44:45], v109 offset:34816
    ds_read_b64_tr_b16 v[46:47], v109 offset:35328
    v_mfma_f32_32x32x16_bf16 v[80:95], v[60:63], v[204:207], v[80:95]
    s_waitcnt lgkmcnt(4)
    v_mfma_f32_32x32x16_bf16 v[64:79], v[32:35], v[208:211], v[64:79]
    ds_read_b64_tr_b16 v[48:49], v108 offset:36864
    ds_read_b64_tr_b16 v[50:51], v108 offset:37376
    ds_read_b64_tr_b16 v[52:53], v109 offset:36864
    ds_read_b64_tr_b16 v[54:55], v109 offset:37376
    v_mfma_f32_32x32x16_bf16 v[80:95], v[36:39], v[208:211], v[80:95]
    s_waitcnt lgkmcnt(4)
    v_mfma_f32_32x32x16_bf16 v[64:79], v[40:43], v[212:215], v[64:79]
    ds_read_b64_tr_b16 v[56:57], v108 offset:38912
    ds_read_b64_tr_b16 v[58:59], v108 offset:39424
    ds_read_b64_tr_b16 v[60:61], v109 offset:38912
    ds_read_b64_tr_b16 v[62:63], v109 offset:39424
    v_mfma_f32_32x32x16_bf16 v[80:95], v[44:47], v[212:215], v[80:95]
    s_waitcnt lgkmcnt(4)
    v_mfma_f32_32x32x16_bf16 v[64:79], v[48:51], v[216:219], v[64:79]
    ds_read_b64_tr_b16 v[32:33], v108 offset:40960
    ds_read_b64_tr_b16 v[34:35], v108 offset:41472
    ds_read_b64_tr_b16 v[36:37], v109 offset:40960
    ds_read_b64_tr_b16 v[38:39], v109 offset:41472
    v_mfma_f32_32x32x16_bf16 v[80:95], v[52:55], v[216:219], v[80:95]
    s_waitcnt lgkmcnt(4)
    v_mfma_f32_32x32x16_bf16 v[64:79], v[56:59], v[220:223], v[64:79]
    ds_read_b64_tr_b16 v[40:41], v108 offset:43008
    ds_read_b64_tr_b16 v[42:43], v108 offset:43520
    ds_read_b64_tr_b16 v[44:45], v109 offset:43008
    ds_read_b64_tr_b16 v[46:47], v109 offset:43520
    v_mfma_f32_32x32x16_bf16 v[80:95], v[60:63], v[220:223], v[80:95]
    s_waitcnt lgkmcnt(4)
    v_mfma_f32_32x32x16_bf16 v[64:79], v[32:35], v[224:227], v[64:79]
    ds_read_b64_tr_b16 v[48:49], v108 offset:45056
    ds_read_b64_tr_b16 v[50:51], v108 offset:45568
    ds_read_b64_tr_b16 v[52:53], v109 offset:45056
    ds_read_b64_tr_b16 v[54:55], v109 offset:45568
    v_mfma_f32_32x32x16_bf16 v[80:95], v[36:39], v[224:227], v[80:95]
    s_waitcnt lgkmcnt(4)
    v_mfma_f32_32x32x16_bf16 v[64:79], v[40:43], v[228:231], v[64:79]
    ds_read_b64_tr_b16 v[56:57], v108 offset:47104
    ds_read_b64_tr_b16 v[58:59], v108 offset:47616
    ds_read_b64_tr_b16 v[60:61], v109 offset:47104
    ds_read_b64_tr_b16 v[62:63], v109 offset:47616
    v_mfma_f32_32x32x16_bf16 v[80:95], v[44:47], v[228:231], v[80:95]
    s_waitcnt lgkmcnt(4)
    v_mfma_f32_32x32x16_bf16 v[64:79], v[48:51], v[232:235], v[64:79]
    ds_read_b64_tr_b16 v[32:33], v108 offset:49152
    ds_read_b64_tr_b16 v[34:35], v108 offset:49664
    ds_read_b64_tr_b16 v[36:37], v109 offset:49152
    ds_read_b64_tr_b16 v[38:39], v109 offset:49664
    v_mfma_f32_32x32x16_bf16 v[80:95], v[52:55], v[232:235], v[80:95]
    s_waitcnt lgkmcnt(4)
    v_mfma_f32_32x32x16_bf16 v[64:79], v[56:59], v[236:239], v[64:79]
    ds_read_b64_tr_b16 v[40:41], v108 offset:51200
    ds_read_b64_tr_b16 v[42:43], v108 offset:51712
    ds_read_b64_tr_b16 v[44:45], v109 offset:51200
    ds_read_b64_tr_b16 v[46:47], v109 offset:51712
    v_mfma_f32_32x32x16_bf16 v[80:95], v[60:63], v[236:239], v[80:95]
    s_waitcnt lgkmcnt(4)
    v_mfma_f32_32x32x16_bf16 v[64:79], v[32:35], v[240:243], v[64:79]
    ds_read_b64_tr_b16 v[48:49], v108 offset:53248
    ds_read_b64_tr_b16 v[50:51], v108 offset:53760
    ds_read_b64_tr_b16 v[52:53], v109 offset:53248
    ds_read_b64_tr_b16 v[54:55], v109 offset:53760
    v_mfma_f32_32x32x16_bf16 v[80:95], v[36:39], v[240:243], v[80:95]
    s_waitcnt lgkmcnt(4)
    v_mfma_f32_32x32x16_bf16 v[64:79], v[40:43], v[244:247], v[64:79]
    ds_read_b64_tr_b16 v[56:57], v108 offset:55296
    ds_read_b64_tr_b16 v[58:59], v108 offset:55808
    ds_read_b64_tr_b16 v[60:61], v109 offset:55296
    ds_read_b64_tr_b16 v[62:63], v109 offset:55808
    v_mfma_f32_32x32x16_bf16 v[80:95], v[44:47], v[244:247], v[80:95]
    s_waitcnt lgkmcnt(4)
    v_mfma_f32_32x32x16_bf16 v[64:79], v[48:51], v[248:251], v[64:79]
    v_mfma_f32_32x32x16_bf16 v[80:95], v[52:55], v[248:251], v[80:95]
    s_waitcnt lgkmcnt(0)
    v_mfma_f32_32x32x16_bf16 v[64:79], v[56:59], v[252:255], v[64:79]
    s_mov_b64 exec, 1
    ds_add_u32 v17, v16 offset:8
    s_mov_b64 exec, -1
    v_mfma_f32_32x32x16_bf16 v[80:95], v[60:63], v[252:255], v[80:95]
    s_branch L_h_phi
L_h_N:
    v_and_b32 v10, 31, v1
    v_and_b32 v11, 0x13, v10
    v_and_b32 v12, 4, v10
    v_lshl_or_b32 v11, v12, 1, v11
    v_lshrrev_b32 v12, 1, v10
    v_and_or_b32 v11, v12, 4, v11
    v_lshrrev_b32 v12, 5, v1
    v_lshrrev_b32 v13, 1, v11
    v_and_b32 v13, 7, v13
    v_lshlrev_b32 v11, 7, v11
    v_add_u32 v11, s81, v11
    v_add_u32 v10, 0, v12
    v_xor_b32 v10, v10, v13
    v_lshl_add_u32 v96, v10, 4, v11
    v_add_u32 v100, 65536, v96
    v_add_u32 v10, 2, v12
    v_xor_b32 v10, v10, v13
    v_lshl_add_u32 v97, v10, 4, v11
    v_add_u32 v101, 65536, v97
    v_add_u32 v10, 4, v12
    v_xor_b32 v10, v10, v13
    v_lshl_add_u32 v98, v10, 4, v11
    v_add_u32 v102, 65536, v98
    v_add_u32 v10, 6, v12
    v_xor_b32 v10, v10, v13
    v_lshl_add_u32 v99, v10, 4, v11
    v_add_u32 v103, 65536, v99
    v_and_b32 v10, 3, v1
    v_bfe_u32 v11, v1, 4, 1
    v_lshl_or_b32 v10, v11, 2, v10
    v_bfe_u32 v11, v1, 2, 2
    v_lshrrev_b32 v12, 5, v1
    v_lshl_add_u32 v11, v12, 3, v11
    v_lshlrev_b32 v11, 7, v11
    v_lshl_add_u32 v11, v10, 3, v11
    v_bfe_u32 v10, v1, 3, 1
    v_lshl_or_b32 v13, v10, 6, v11
    v_add_u32 v108, 98304, v13
    v_xor_b32 v109, 64, v108
    s_lshl_b32 s75, s61, 2
    s_add_u32 s75, s75, s3
    s_lshl_b32 s75, s75, 11
    s_add_u32 s77, s75, 9699328
    s_sub_u32 s73, s62, 7
    s_lshl_b32 s73, s73, 6
    s_add_u32 s73, s73, 0
    v_and_b32 v14, 31, v1
    v_add_u32 v14, s73, v14
    s_mov_b32 s78, 2341
    v_mul_lo_u32 v10, s78, v14
    v_lshrrev_b32 v10, 16, v10
    v_mul_u32_u24 v11, 28, v10
    v_sub_u32 v11, v14, v11
    v_and_b32 v12, 1, v10
    v_lshlrev_b32 v12, 2, v12
    v_add_u32 v11, v11, v12
    v_and_b32 v13, 0x13, v11
    v_and_b32 v12, 4, v11
    v_lshl_or_b32 v13, v12, 1, v13
    v_lshrrev_b32 v12, 1, v11
    v_and_or_b32 v13, v12, 4, v13
    v_lshlrev_b32 v10, 17, v10
    v_lshl_add_u32 v10, v13, 4, v10
    v_lshrrev_b32 v11, 5, v1
    v_lshl_add_u32 v10, v11, 9, v10
    v_add_u32 v110, s77, v10
    s_sub_u32 s73, s62, 7
    s_lshl_b32 s73, s73, 6
    s_add_u32 s73, s73, 32
    v_and_b32 v14, 31, v1
    v_add_u32 v14, s73, v14
    s_mov_b32 s78, 2341
    v_mul_lo_u32 v10, s78, v14
    v_lshrrev_b32 v10, 16, v10
    v_mul_u32_u24 v11, 28, v10
    v_sub_u32 v11, v14, v11
    v_and_b32 v12, 1, v10
    v_lshlrev_b32 v12, 2, v12
    v_add_u32 v11, v11, v12
    v_and_b32 v13, 0x13, v11
    v_and_b32 v12, 4, v11
    v_lshl_or_b32 v13, v12, 1, v13
    v_lshrrev_b32 v12, 1, v11
    v_and_or_b32 v13, v12, 4, v13
    v_lshlrev_b32 v10, 17, v10
    v_lshl_add_u32 v10, v13, 4, v10
    v_lshrrev_b32 v11, 5, v1
    v_lshl_add_u32 v10, v11, 9, v10
    v_add_u32 v111, s77, v10
    s_waitcnt vmcnt(8)
    s_barrier
    ds_read_b128 v[144:147], v96 offset:0
    ds_read_b128 v[148:151], v97 offset:0
    ds_read_b128 v[152:155], v98 offset:0
    ds_read_b128 v[156:159], v99 offset:0
    s_add_u32 m0, s81, 65536
    s_mov_b32 s73, 256
    buffer_load_dwordx4 v3, s[4:7], s73 offen offset:0 lds
    buffer_load_dwordx4 v4, s[4:7], s73 offen offset:1024 lds
    buffer_load_dwordx4 v5, s[4:7], s73 offen offset:2048 lds
    buffer_load_dwordx4 v6, s[4:7], s73 offen offset:3072 lds
    s_add_u32 m0, s82, 81920
    s_mov_b32 s73, 344064
    buffer_load_dwordx4 v7, s[8:11], s73 offen offset:0 lds
    buffer_load_dwordx4 v8, s[8:11], s73 offen offset:1024 lds
    s_add_u32 m0, s82, 90112
    s_mov_b32 s73, 344064
    buffer_load_dwordx4 v7, s[12:15], s73 offen offset:0 lds
    buffer_load_dwordx4 v8, s[12:15], s73 offen offset:1024 lds
    s_add_u32 m0, s81, 98304
    s_mov_b32 s73, 384
    buffer_load_dwordx4 v3, s[4:7], s73 offen offset:0 lds
    buffer_load_dwordx4 v4, s[4:7], s73 offen offset:1024 lds
    buffer_load_dwordx4 v5, s[4:7], s73 offen offset:2048 lds
    buffer_load_dwordx4 v6, s[4:7], s73 offen offset:3072 lds
    s_add_u32 m0, s82, 114688
    s_mov_b32 s73, 516096
    buffer_load_dwordx4 v7, s[8:11], s73 offen offset:0 lds
    buffer_load_dwordx4 v8, s[8:11], s73 offen offset:1024 lds
    s_add_u32 m0, s82, 122880
    s_mov_b32 s73, 516096
    buffer_load_dwordx4 v7, s[12:15], s73 offen offset:0 lds
    buffer_load_dwordx4 v8, s[12:15], s73 offen offset:1024 lds
    s_waitcnt vmcnt(16)
    s_waitcnt lgkmcnt(0)
    s_barrier
    ds_read_b128 v[160:163], v96 offset:32768
    ds_read_b128 v[164:167], v97 offset:32768
    ds_read_b128 v[168:171], v98 offset:32768
    ds_read_b128 v[172:175], v99 offset:32768
    s_add_u32 m0, s81, 0
    s_mov_b32 s73, 512
    buffer_load_dwordx4 v3, s[4:7], s73 offen offset:0 lds
    buffer_load_dwordx4 v4, s[4:7], s73 offen offset:1024 lds
    buffer_load_dwordx4 v5, s[4:7], s73 offen offset:2048 lds
    buffer_load_dwordx4 v6, s[4:7], s73 offen offset:3072 lds
    s_add_u32 m0, s82, 16384
    s_mov_b32 s73, 688128
    buffer_load_dwordx4 v7, s[8:11], s73 offen offset:0 lds
    buffer_load_dwordx4 v8, s[8:11], s73 offen offset:1024 lds
    s_add_u32 m0, s82, 24576
    s_mov_b32 s73, 688128
    buffer_load_dwordx4 v7, s[12:15], s73 offen offset:0 lds
    buffer_load_dwordx4 v8, s[12:15], s73 offen offset:1024 lds
    s_waitcnt vmcnt(16)
    s_waitcnt lgkmcnt(0)
    s_barrier
    ds_read_b128 v[176:179], v100 offset:0
    ds_read_b128 v[180:183], v101 offset:0
    ds_read_b128 v[184:187], v102 offset:0
    ds_read_b128 v[188:191], v103 offset:0
    s_add_u32 m0, s81, 32768
    s_mov_b32 s73, 640
    buffer_load_dwordx4 v3, s[4:7], s73 offen offset:0 lds
    buffer_load_dwordx4 v4, s[4:7], s73 offen offset:1024 lds
    buffer_load_dwordx4 v5, s[4:7], s73 offen offset:2048 lds
    buffer_load_dwordx4 v6, s[4:7], s73 offen offset:3072 lds
    s_add_u32 m0, s82, 49152
    s_mov_b32 s73, 860160
    buffer_load_dwordx4 v7, s[8:11], s73 offen offset:0 lds
    buffer_load_dwordx4 v8, s[8:11], s73 offen offset:1024 lds
    s_add_u32 m0, s82, 57344
    s_mov_b32 s73, 860160
    buffer_load_dwordx4 v7, s[12:15], s73 offen offset:0 lds
    buffer_load_dwordx4 v8, s[12:15], s73 offen offset:1024 lds
    s_waitcnt vmcnt(16)
    s_waitcnt lgkmcnt(0)
    s_barrier
    ds_read_b128 v[192:195], v100 offset:32768
    ds_read_b128 v[196:199], v101 offset:32768
    ds_read_b128 v[200:203], v102 offset:32768
    ds_read_b128 v[204:207], v103 offset:32768
    s_add_u32 m0, s81, 65536
    s_mov_b32 s73, 768
    buffer_load_dwordx4 v3, s[4:7], s73 offen offset:0 lds
    buffer_load_dwordx4 v4, s[4:7], s73 offen offset:1024 lds
    buffer_load_dwordx4 v5, s[4:7], s73 offen offset:2048 lds
    buffer_load_dwordx4 v6, s[4:7], s73 offen offset:3072 lds
    s_add_u32 m0, s82, 81920
    s_mov_b32 s73, 1032192
    buffer_load_dwordx4 v7, s[8:11], s73 offen offset:0 lds
    buffer_load_dwordx4 v8, s[8:11], s73 offen offset:1024 lds
    s_add_u32 m0, s82, 90112
    s_mov_b32 s73, 1032192
    buffer_load_dwordx4 v7, s[12:15], s73 offen offset:0 lds
    buffer_load_dwordx4 v8, s[12:15], s73 offen offset:1024 lds
    s_waitcnt vmcnt(16)
    s_waitcnt lgkmcnt(0)
    s_barrier
    ds_read_b128 v[208:211], v96 offset:0
    ds_read_b128 v[212:215], v97 offset:0
    ds_read_b128 v[216:219], v98 offset:0
    ds_read_b128 v[220:223], v99 offset:0
    s_add_u32 m0, s82, 98304
    s_mov_b32 s73, 0
    buffer_load_dwordx4 v7, s[16:19], s73 offen offset:0 lds
    buffer_load_dwordx4 v8, s[16:19], s73 offen offset:1024 lds
    s_add_u32 m0, s82, 106496
    s_mov_b32 s73, 172032
    buffer_load_dwordx4 v7, s[16:19], s73 offen offset:0 lds
    buffer_load_dwordx4 v8, s[16:19], s73 offen offset:1024 lds
    s_add_u32 m0, s82, 114688
    s_mov_b32 s73, 344064
    buffer_load_dwordx4 v7, s[16:19], s73 offen offset:0 lds
    buffer_load_dwordx4 v8, s[16:19], s73 offen offset:1024 lds
    s_add_u32 m0, s82, 122880
    s_mov_b32 s73, 516096
    buffer_load_dwordx4 v7, s[16:19], s73 offen offset:0 lds
    buffer_load_dwordx4 v8, s[16:19], s73 offen offset:1024 lds
    s_waitcnt vmcnt(16)
    s_waitcnt lgkmcnt(0)
    s_barrier
    ds_read_b128 v[224:227], v96 offset:32768
    ds_read_b128 v[228:231], v97 offset:32768
    ds_read_b128 v[232:235], v98 offset:32768
    ds_read_b128 v[236:239], v99 offset:32768
    s_add_u32 m0, s82, 131072
    s_mov_b32 s73, 688128
    buffer_load_dwordx4 v7, s[16:19], s73 offen offset:0 lds
    buffer_load_dwordx4 v8, s[16:19], s73 offen offset:1024 lds
    s_add_u32 m0, s82, 139264
    s_mov_b32 s73, 860160
    buffer_load_dwordx4 v7, s[16:19], s73 offen offset:0 lds
    buffer_load_dwordx4 v8, s[16:19], s73 offen offset:1024 lds
    s_add_u32 m0, s82, 147456
    s_mov_b32 s73, 1032192
    buffer_load_dwordx4 v7, s[16:19], s73 offen offset:0 lds
    buffer_load_dwordx4 v8, s[16:19], s73 offen offset:1024 lds
    s_waitcnt vmcnt(14)
    s_waitcnt lgkmcnt(0)
    s_barrier
    ds_read_b128 v[240:243], v100 offset:0
    ds_read_b128 v[244:247], v101 offset:0
    ds_read_b128 v[248:251], v102 offset:0
    ds_read_b128 v[252:255], v103 offset:0
    s_waitcnt vmcnt(0)
    s_waitcnt lgkmcnt(0)
    s_add_u32 s60, s60, 0x9e3779b1
    v_mov_b32 v30, s60
    s_mov_b64 exec, 1
    ds_add_u32 v17, v16 offset:4
    s_mov_b64 exec, -1
L_spin_3:
    ds_read_b32 v2, v17 offset:4
    s_waitcnt lgkmcnt(0)
    v_readfirstlane_b32 s83, v2
    s_cmp_ge_u32 s83, 4
    s_cbranch_scc1 L_spun_4
    s_sub_u32 s79, s79, 1
    s_cbranch_scc0 L_spin_3
    s_mov_b32 s79, 0
L_spun_4:
    ds_read_b64_tr_b16 v[32:33], v108 offset:0
    ds_read_b64_tr_b16 v[34:35], v108 offset:512
    ds_read_b64_tr_b16 v[36:37], v109 offset:0
    ds_read_b64_tr_b16 v[38:39], v109 offset:512
    ds_read_b64_tr_b16 v[40:41], v108 offset:2048
    ds_read_b64_tr_b16 v[42:43], v108 offset:2560
    ds_read_b64_tr_b16 v[44:45], v109 offset:2048
    ds_read_b64_tr_b16 v[46:47], v109 offset:2560
    s_mul_i32 s75, s3, 14336
    s_mul_i32 s76, s3, 100352
    s_waitcnt lgkmcnt(4)
    v_mfma_f32_32x32x16_bf16 v[64:79], v[144:147], v[32:35], 0
    ds_read_b64_tr_b16 v[48:49], v108 offset:4096
    ds_read_b64_tr_b16 v[50:51], v108 offset:4608
    ds_read_b64_tr_b16 v[52:53], v109 offset:4096
    ds_read_b64_tr_b16 v[54:55], v109 offset:4608
    v_mfma_f32_32x32x16_bf16 v[80:95], v[144:147], v[36:39], 0
    s_waitcnt lgkmcnt(4)
    v_mfma_f32_32x32x16_bf16 v[64:79], v[148:151], v[40:43], v[64:79]
    ds_read_b64_tr_b16 v[56:57], v108 offset:6144
    ds_read_b64_tr_b16 v[58:59], v108 offset:6656
    ds_read_b64_tr_b16 v[60:61], v109 offset:6144
    ds_read_b64_tr_b16 v[62:63], v109 offset:6656
    v_mfma_f32_32x32x16_bf16 v[80:95], v[148:151], v[44:47], v[80:95]
    s_waitcnt lgkmcnt(4)
    v_mfma_f32_32x32x16_bf16 v[64:79], v[152:155], v[48:51], v[64:79]
    ds_read_b64_tr_b16 v[32:33], v108 offset:8192
    ds_read_b64_tr_b16 v[34:35], v108 offset:8704
    ds_read_b64_tr_b16 v[36:37], v109 offset:8192
    ds_read_b64_tr_b16 v[38:39], v109 offset:8704
    v_mfma_f32_32x32x16_bf16 v[80:95], v[152:155], v[52:55], v[80:95]
    s_waitcnt lgkmcnt(4)
    v_mfma_f32_32x32x16_bf16 v[64:79], v[156:159], v[56:59], v[64:79]
    ds_read_b64_tr_b16 v[40:41], v108 offset:10240
    ds_read_b64_tr_b16 v[42:43], v108 offset:10752
    ds_read_b64_tr_b16 v[44:45], v109 offset:10240
    ds_read_b64_tr_b16 v[46:47], v109 offset:10752
    v_mfma_f32_32x32x16_bf16 v[80:95], v[156:159], v[60:63], v[80:95]
    s_waitcnt lgkmcnt(4)
    v_mfma_f32_32x32x16_bf16 v[64:79], v[160:163], v[32:35], v[64:79]
    ds_read_b64_tr_b16 v[48:49], v108 offset:12288
    ds_read_b64_tr_b16 v[50:51], v108 offset:12800
    ds_read_b64_tr_b16 v[52:53], v109 offset:12288
    ds_read_b64_tr_b16 v[54:55], v109 offset:12800
    v_mfma_f32_32x32x16_bf16 v[80:95], v[160:163], v[36:39], v[80:95]
    s_waitcnt lgkmcnt(4)
    v_mfma_f32_32x32x16_bf16 v[64:79], v[164:167], v[40:43], v[64:79]
    ds_read_b64_tr_b16 v[56:57], v108 offset:14336
    ds_read_b64_tr_b16 v[58:59], v108 offset:14848
    ds_read_b64_tr_b16 v[60:61], v109 offset:14336
    ds_read_b64_tr_b16 v[62:63], v109 offset:14848
    v_mfma_f32_32x32x16_bf16 v[80:95], v[164:167], v[44:47], v[80:95]
    s_waitcnt lgkmcnt(4)
    v_mfma_f32_32x32x16_bf16 v[64:79], v[168:171], v[48:51], v[64:79]
    ds_read_b64_tr_b16 v[32:33], v108 offset:16384
    ds_read_b64_tr_b16 v[34:35], v108 offset:16896
    ds_read_b64_tr_b16 v[36:37], v109 offset:16384
    ds_read_b64_tr_b16 v[38:39], v109 offset:16896
    v_mfma_f32_32x32x16_bf16 v[80:95], v[168:171], v[52:55], v[80:95]
    s_waitcnt lgkmcnt(4)
    v_mfma_f32_32x32x16_bf16 v[64:79], v[172:175], v[56:59], v[64:79]
    ds_read_b64_tr_b16 v[40:41], v108 offset:18432
    ds_read_b64_tr_b16 v[42:43], v108 offset:18944
    ds_read_b64_tr_b16 v[44:45], v109 offset:18432
    ds_read_b64_tr_b16 v[46:47], v109 offset:18944
    v_mfma_f32_32x32x16_bf16 v[80:95], v[172:175], v[60:63], v[80:95]
    s_waitcnt lgkmcnt(4)
    v_mfma_f32_32x32x16_bf16 v[64:79], v[176:179], v[32:35], v[64:79]
    ds_read_b64_tr_b16 v[48:49], v108 offset:20480
    ds_read_b64_tr_b16 v[50:51], v108 offset:20992
    ds_read_b64_tr_b16 v[52:53], v109 offset:20480
    ds_read_b64_tr_b16 v[54:55], v109 offset:20992
    v_mfma_f32_32x32x16_bf16 v[80:95], v[176:179], v[36:39], v[80:95]
    s_waitcnt lgkmcnt(4)
    v_mfma_f32_32x32x16_bf16 v[64:79], v[180:183], v[40:43], v[64:79]
    ds_read_b64_tr_b16 v[56:57], v108 offset:22528
    ds_read_b64_tr_b16 v[58:59], v108 offset:23040
    ds_read_b64_tr_b16 v[60:61], v109 offset:22528
    ds_read_b64_tr_b16 v[62:63], v109 offset:23040
    v_mfma_f32_32x32x16_bf16 v[80:95], v[180:183], v[44:47], v[80:95]
    s_waitcnt lgkmcnt(4)
    v_mfma_f32_32x32x16_bf16 v[64:79], v[184:187], v[48:51], v[64:79]
    ds_read_b64_tr_b16 v[32:33], v108 offset:24576
    ds_read_b64_tr_b16 v[34:35], v108 offset:25088
    ds_read_b64_tr_b16 v[36:37], v109 offset:24576
    ds_read_b64_tr_b16 v[38:39], v109 offset:25088
    v_mfma_f32_32x32x16_bf16 v[80:95], v[184:187], v[52:55], v[80:95]
    s_waitcnt lgkmcnt(4)
    v_mfma_f32_32x32x16_bf16 v[64:79], v[188:191], v[56:59], v[64:79]
    ds_read_b64_tr_b16 v[40:41], v108 offset:26624
    ds_read_b64_tr_b16 v[42:43], v108 offset:27136
    ds_read_b64_tr_b16 v[44:45], v109 offset:26624
    ds_read_b64_tr_b16 v[46:47], v109 offset:27136
    v_mfma_f32_32x32x16_bf16 v[80:95], v[188:191], v[60:63], v[80:95]
    s_waitcnt lgkmcnt(4)
    v_mfma_f32_32x32x16_bf16 v[64:79], v[192:195], v[32:35], v[64:79]
    ds_read_b64_tr_b16 v[48:49], v108 offset:28672
    ds_read_b64_tr_b16 v[50:51], v108 offset:29184
    ds_read_b64_tr_b16 v[52:53], v109 offset:28672
    ds_read_b64_tr_b16 v[54:55], v109 offset:29184
    v_mfma_f32_32x32x16_bf16 v[80:95], v[192:195], v[36:39], v[80:95]
    s_waitcnt lgkmcnt(4)
    v_mfma_f32_32x32x16_bf16 v[64:79], v[196:199], v[40:43], v[64:79]
    ds_read_b64_tr_b16 v[56:57], v108 offset:30720
    ds_read_b64_tr_b16 v[58:59], v108 offset:31232
    ds_read_b64_tr_b16 v[60:61], v109 offset:30720
    ds_read_b64_tr_b16 v[62:63], v109 offset:31232
    v_mfma_f32_32x32x16_bf16 v[80:95], v[196:199], v[44:47], v[80:95]
    s_waitcnt lgkmcnt(4)
    v_mfma_f32_32x32x16_bf16 v[64:79], v[200:203], v[48:51], v[64:79]
    ds_read_b64_tr_b16 v[32:33], v108 offset:32768
    ds_read_b64_tr_b16 v[34:35], v108 offset:33280
    ds_read_b64_tr_b16 v[36:37], v109 offset:32768
    ds_read_b64_tr_b16 v[38:39], v109 offset:33280
    v_mfma_f32_32x32x16_bf16 v[80:95], v[200:203], v[52:55], v[80:95]
    s_waitcnt lgkmcnt(4)
    v_mfma_f32_32x32x16_bf16 v[64:79], v[204:207], v[56:59], v[64:79]
    ds_read_b64_tr_b16 v[40:41], v108 offset:34816
    ds_read_b64_tr_b16 v[42:43], v108 offset:35328
    ds_read_b64_tr_b16 v[44:45], v109 offset:34816
    ds_read_b64_tr_b16 v[46:47], v109 offset:35328
    v_mfma_f32_32x32x16_bf16 v[80:95], v[204:207], v[60:63], v[80:95]
    s_waitcnt lgkmcnt(4)
    v_mfma_f32_32x32x16_bf16 v[64:79], v[208:211], v[32:35], v[64:79]
    ds_read_b64_tr_b16 v[48:49], v108 offset:36864
    ds_read_b64_tr_b16 v[50:51], v108 offset:37376
    ds_read_b64_tr_b16 v[52:53], v109 offset:36864
    ds_read_b64_tr_b16 v[54:55], v109 offset:37376
    v_mfma_f32_32x32x16_bf16 v[80:95], v[208:211], v[36:39], v[80:95]
    s_waitcnt lgkmcnt(4)
    v_mfma_f32_32x32x16_bf16 v[64:79], v[212:215], v[40:43], v[64:79]
    ds_read_b64_tr_b16 v[56:57], v108 offset:38912
    ds_read_b64_tr_b16 v[58:59], v108 offset:39424
    ds_read_b64_tr_b16 v[60:61], v109 offset:38912
    ds_read_b64_tr_b16 v[62:63], v109 offset:39424
    v_mfma_f32_32x32x16_bf16 v[80:95], v[212:215], v[44:47], v[80:95]
    s_waitcnt lgkmcnt(4)
    v_mfma_f32_32x32x16_bf16 v[64:79], v[216:219], v[48:51], v[64:79]
    ds_read_b64_tr_b16 v[32:33], v108 offset:40960
    ds_read_b64_tr_b16 v[34:35], v108 offset:41472
    ds_read_b64_tr_b16 v[36:37], v109 offset:40960
    ds_read_b64_tr_b16 v[38:39], v109 offset:41472
    v_mfma_f32_32x32x16_bf16 v[80:95], v[216:219], v[52:55], v[80:95]
    s_waitcnt lgkmcnt(4)
    v_mfma_f32_32x32x16_bf16 v[64:79], v[220:223], v[56:59], v[64:79]
    ds_read_b64_tr_b16 v[40:41], v108 offset:43008
    ds_read_b64_tr_b16 v[42:43], v108 offset:43520
    ds_read_b64_tr_b16 v[44:45], v109 offset:43008
    ds_read_b64_tr_b16 v[46:47], v109 offset:43520
    v_mfma_f32_32x32x16_bf16 v[80:95], v[220:223], v[60:63], v[80:95]
    s_waitcnt lgkmcnt(4)
    v_mfma_f32_32x32x16_bf16 v[64:79], v[224:227], v[32:35], v[64:79]
    ds_read_b64_tr_b16 v[48:49], v108 offset:45056
    ds_read_b64_tr_b16 v[50:51], v108 offset:45568
    ds_read_b64_tr_b16 v[52:53], v109 offset:45056
    ds_read_b64_tr_b16 v[54:55], v109 offset:45568
    v_mfma_f32_32x32x16_bf16 v[80:95], v[224:227], v[36:39], v[80:95]
    s_waitcnt lgkmcnt(4)
    v_mfma_f32_32x32x16_bf16 v[64:79], v[228:231], v[40:43], v[64:79]
    ds_read_b64_tr_b16 v[56:57], v108 offset:47104
    ds_read_b64_tr_b16 v[58:59], v108 offset:47616
    ds_read_b64_tr_b16 v[60:61], v109 offset:47104
    ds_read_b64_tr_b16 v[62:63], v109 offset:47616
    v_mfma_f32_32x32x16_bf16 v[80:95], v[228:231], v[44:47], v[80:95]
    s_waitcnt lgkmcnt(4)
    v_mfma_f32_32x32x16_bf16 v[64:79], v[232:235], v[48:51], v[64:79]
    ds_read_b64_tr_b16 v[32:33], v108 offset:49152
    ds_read_b64_tr_b16 v[34:35], v108 offset:49664
    ds_read_b64_tr_b16 v[36:37], v109 offset:49152
    ds_read_b64_tr_b16 v[38:39], v109 offset:49664
    v_mfma_f32_32x32x16_bf16 v[80:95], v[232:235], v[52:55], v[80:95]
    s_waitcnt lgkmcnt(4)
    v_mfma_f32_32x32x16_bf16 v[64:79], v[236:239], v[56:59], v[64:79]
    ds_read_b64_tr_b16 v[40:41], v108 offset:51200
    ds_read_b64_tr_b16 v[42:43], v108 offset:51712
    ds_read_b64_tr_b16 v[44:45], v109 offset:51200
    ds_read_b64_tr_b16 v[46:47], v109 offset:51712
    v_mfma_f32_32x32x16_bf16 v[80:95], v[236:239], v[60:63], v[80:95]
    s_waitcnt lgkmcnt(4)
    v_mfma_f32_32x32x16_bf16 v[64:79], v[240:243], v[32:35], v[64:79]
    ds_read_b64_tr_b16 v[48:49], v108 offset:53248
    ds_read_b64_tr_b16 v[50:51], v108 offset:53760
    ds_read_b64_tr_b16 v[52:53], v109 offset:53248
    ds_read_b64_tr_b16 v[54:55], v109 offset:53760
    v_mfma_f32_32x32x16_bf16 v[80:95], v[240:243], v[36:39], v[80:95]
    s_waitcnt lgkmcnt(4)
    v_mfma_f32_32x32x16_bf16 v[64:79], v[244:247], v[40:43], v[64:79]
    ds_read_b64_tr_b16 v[56:57], v108 offset:55296
    ds_read_b64_tr_b16 v[58:59], v108 offset:55808
    ds_read_b64_tr_b16 v[60:61], v109 offset:55296
    ds_read_b64_tr_b16 v[62:63], v109 offset:55808
    v_mfma_f32_32x32x16_bf16 v[80:95], v[244:247], v[44:47], v[80:95]
    s_waitcnt lgkmcnt(4)
    v_mfma_f32_32x32x16_bf16 v[64:79], v[248:251], v[48:51], v[64:79]
    v_mfma_f32_32x32x16_bf16 v[80:95], v[248:251], v[52:55], v[80:95]
    s_waitcnt lgkmcnt(0)
    v_mfma_f32_32x32x16_bf16 v[64:79], v[252:255], v[56:59], v[64:79]
    s_mov_b64 exec, 1
    ds_add_u32 v17, v16 offset:8
    s_mov_b64 exec, -1
    v_mfma_f32_32x32x16_bf16 v[80:95], v[252:255], v[60:63], v[80:95]
L_h_phi:
    s_mov_b32 s84, 0x3fb8aa3b
    s_mov_b32 s85, s84
    s_mov_b32 s94, 0x358637bd
    s_mov_b32 s95, s94
    s_nop 7
    v_pk_mul_f32 v[112:113], v[64:65], s[84:85]
    v_pk_mul_f32 v[114:115], v[66:67], s[84:85]
    v_pk_mul_f32 v[116:117], v[68:69], s[84:85]
    v_pk_mul_f32 v[118:119], v[70:71], s[84:85]
    v_pk_mul_f32 v[120:121], v[72:73], s[84:85]
    v_pk_mul_f32 v[122:123], v[74:75], s[84:85]
    v_pk_mul_f32 v[124:125], v[76:77], s[84:85]
    v_pk_mul_f32 v[126:127], v[78:79], s[84:85]
    v_exp_f32_e64 v112, v112 clamp
    v_exp_f32_e64 v113, v113 clamp
    v_exp_f32_e64 v114, v114 clamp
    v_exp_f32_e64 v115, v115 clamp
    v_exp_f32_e64 v116, v116 clamp
    v_exp_f32_e64 v117, v117 clamp
    v_exp_f32_e64 v118, v118 clamp
    v_exp_f32_e64 v119, v119 clamp
    v_exp_f32_e64 v120, v120 clamp
    v_exp_f32_e64 v121, v121 clamp
    v_exp_f32_e64 v122, v122 clamp
    v_exp_f32_e64 v123, v123 clamp
    v_exp_f32_e64 v124, v124 clamp
    v_exp_f32_e64 v125, v125 clamp
    v_exp_f32_e64 v126, v126 clamp
    v_exp_f32_e64 v127, v127 clamp
    v_max_f32 v64, 0, v64
    v_max_f32 v65, 0, v65
    v_max_f32 v66, 0, v66
    v_max_f32 v67, 0, v67
    v_max_f32 v68, 0, v68
    v_max_f32 v69, 0, v69
    v_max_f32 v70, 0, v70
    v_max_f32 v71, 0, v71
    v_max_f32 v72, 0, v72
    v_max_f32 v73, 0, v73
    v_max_f32 v74, 0, v74
    v_max_f32 v75, 0, v75
    v_max_f32 v76, 0, v76
    v_max_f32 v77, 0, v77
    v_max_f32 v78, 0, v78
    v_max_f32 v79, 0, v79
    v_pk_add_f32 v[64:65], v[64:65], v[112:113]
    v_pk_add_f32 v[66:67], v[66:67], v[114:115]
    v_pk_add_f32 v[68:69], v[68:69], v[116:117]
    v_pk_add_f32 v[70:71], v[70:71], v[118:119]
    v_pk_add_f32 v[72:73], v[72:73], v[120:121]
    v_pk_add_f32 v[74:75], v[74:75], v[122:123]
    v_pk_add_f32 v[76:77], v[76:77], v[124:125]
    v_pk_add_f32 v[78:79], v[78:79], v[126:127]
    v_pk_add_f32 v[64:65], v[64:65], s[94:95]
    v_pk_add_f32 v[66:67], v[66:67], s[94:95]
    v_pk_add_f32 v[68:69], v[68:69], s[94:95]
    v_pk_add_f32 v[70:71], v[70:71], s[94:95]
    v_pk_add_f32 v[72:73], v[72:73], s[94:95]
    v_pk_add_f32 v[74:75], v[74:75], s[94:95]
    v_pk_add_f32 v[76:77], v[76:77], s[94:95]
    v_pk_add_f32 v[78:79], v[78:79], s[94:95]
    v_cvt_pk_bf16_f32 v32, v64, v65
    v_cvt_pk_bf16_f32 v33, v66, v67
    v_cvt_pk_bf16_f32 v34, v68, v69
    v_cvt_pk_bf16_f32 v35, v70, v71
    v_cvt_pk_bf16_f32 v36, v72, v73
    v_cvt_pk_bf16_f32 v37, v74, v75
    v_cvt_pk_bf16_f32 v38, v76, v77
    v_cvt_pk_bf16_f32 v39, v78, v79
    v_pk_mul_f32 v[112:113], v[80:81], s[84:85]
    v_pk_mul_f32 v[114:115], v[82:83], s[84:85]
    v_pk_mul_f32 v[116:117], v[84:85], s[84:85]
    v_pk_mul_f32 v[118:119], v[86:87], s[84:85]
    v_pk_mul_f32 v[120:121], v[88:89], s[84:85]
    v_pk_mul_f32 v[122:123], v[90:91], s[84:85]
    v_pk_mul_f32 v[124:125], v[92:93], s[84:85]
    v_pk_mul_f32 v[126:127], v[94:95], s[84:85]
    v_exp_f32_e64 v112, v112 clamp
    v_exp_f32_e64 v113, v113 clamp
    v_exp_f32_e64 v114, v114 clamp
    v_exp_f32_e64 v115, v115 clamp
    v_exp_f32_e64 v116, v116 clamp
    v_exp_f32_e64 v117, v117 clamp
    v_exp_f32_e64 v118, v118 clamp
    v_exp_f32_e64 v119, v119 clamp
    v_exp_f32_e64 v120, v120 clamp
    v_exp_f32_e64 v121, v121 clamp
    v_exp_f32_e64 v122, v122 clamp
    v_exp_f32_e64 v123, v123 clamp
    v_exp_f32_e64 v124, v124 clamp
    v_exp_f32_e64 v125, v125 clamp
    v_exp_f32_e64 v126, v126 clamp
    v_exp_f32_e64 v127, v127 clamp
    v_max_f32 v80, 0, v80
    v_max_f32 v81, 0, v81
    v_max_f32 v82, 0, v82
    v_max_f32 v83, 0, v83
    v_max_f32 v84, 0, v84
    v_max_f32 v85, 0, v85
    v_max_f32 v86, 0, v86
    v_max_f32 v87, 0, v87
    v_max_f32 v88, 0, v88
    v_max_f32 v89, 0, v89
    v_max_f32 v90, 0, v90
    v_max_f32 v91, 0, v91
    v_max_f32 v92, 0, v92
    v_max_f32 v93, 0, v93
    v_max_f32 v94, 0, v94
    v_max_f32 v95, 0, v95
    v_pk_add_f32 v[80:81], v[80:81], v[112:113]
    v_pk_add_f32 v[82:83], v[82:83], v[114:115]
    v_pk_add_f32 v[84:85], v[84:85], v[116:117]
    v_pk_add_f32 v[86:87], v[86:87], v[118:119]
    v_pk_add_f32 v[88:89], v[88:89], v[120:121]
    v_pk_add_f32 v[90:91], v[90:91], v[122:123]
    v_pk_add_f32 v[92:93], v[92:93], v[124:125]
    v_pk_add_f32 v[94:95], v[94:95], v[126:127]
    v_pk_add_f32 v[80:81], v[80:81], s[94:95]
    v_pk_add_f32 v[82:83], v[82:83], s[94:95]
    v_pk_add_f32 v[84:85], v[84:85], s[94:95]
    v_pk_add_f32 v[86:87], v[86:87], s[94:95]
    v_pk_add_f32 v[88:89], v[88:89], s[94:95]
    v_pk_add_f32 v[90:91], v[90:91], s[94:95]
    v_pk_add_f32 v[92:93], v[92:93], s[94:95]
    v_pk_add_f32 v[94:95], v[94:95], s[94:95]
    v_cvt_pk_bf16_f32 v40, v80, v81
    v_cvt_pk_bf16_f32 v41, v82, v83
    v_cvt_pk_bf16_f32 v42, v84, v85
    v_cvt_pk_bf16_f32 v43, v86, v87
    v_cvt_pk_bf16_f32 v44, v88, v89
    v_cvt_pk_bf16_f32 v45, v90, v91
    v_cvt_pk_bf16_f32 v46, v92, v93
    v_cvt_pk_bf16_f32 v47, v94, v95
    s_branch L_h_join
L_h_gate:
    s_setprio 1
    s_mov_b32 s73, 16711680
    s_load_dword s60, s[58:59], s73
    s_and_b32 s73, s2, 7
    s_lshr_b32 s74, s2, 3
    s_and_b32 s66, s74, 1
    s_lshl_b32 s75, s73, 1
    s_add_u32 s63, s75, s66
    s_lshr_b32 s64, s74, 1
    s_mul_i32 s75, s63, 7
    s_lshr_b32 s65, s75, 1
    s_mul_i32 s75, s74, 37
    s_lshr_b32 s75, s75, 8
    s_mul_i32 s76, s75, 7
    s_sub_u32 s68, s74, s76
    s_lshl_b32 s76, s73, 2
    s_add_u32 s67, s76, s75
    s_cmp_lt_u32 s74, 28
    s_cselect_b32 s69, 1, 0
    s_cselect_b32 s67, s67, 0
    s_mul_i32 s75, s63, 28
    s_lshr_b32 s70, s75, 6
    s_add_u32 s75, s75, 27
    s_lshr_b32 s71, s75, 6
    s_mov_b32 s79, 262144
    s_mov_b32 s80, 0
    s_lshl_b32 s75, s62, 4
    s_add_u32 s75, s75, s61
    s_lshl_b32 s97, s75, 7
    s_lshl_b32 s75, s63, 4
    s_add_u32 s75, s75, s64
    s_lshl_b32 s96, s75, 7
    v_cmp_eq_u32 s[90:91], 0, v1
    v_mov_b32 v27, 0
    v_mov_b32 v17, 155648
    v_mov_b32 v16, 1
    s_lshl_b32 s77, s68, 7
    v_add3_u32 v26, s77, v13, v9
    s_lshl_b32 s75, s62, 7
    s_add_u32 s16, s48, s75
    s_addc_u32 s17, s49, 0
    s_sub_u32 s18, 1204224, s75
    s_mov_b32 s19, 0x20000
    s_mov_b32 s20, s58
    s_mov_b32 s21, s59
    s_mov_b32 s22, 17825792
    s_mov_b32 s23, 0x20000
    s_mov_b32 s24, s54
    s_mov_b32 s25, s55
    s_mov_b32 s26, 1835008
    s_mov_b32 s27, 0x20000
    s_mov_b32 s28, s44
    s_mov_b32 s29, s45
    s_mov_b32 s30, 401408
    s_mov_b32 s31, 0x20000
    s_mov_b32 s32, s50
    s_mov_b32 s33, s51
    s_mov_b32 s34, 401408
    s_mov_b32 s35, 0x20000
    v_mov_b32 v110, 1073741824
    v_mov_b32 v111, 1073741824
    s_waitcnt lgkmcnt(0)
    s_add_u32 s60, s60, 0x9e3779b1
    v_mov_b32 v30, s60
    s_barrier
    s_mov_b64 exec, 1
    ds_add_u32 v17, v16 offset:8
    s_mov_b64 exec, -1
    s_sleep 16
    s_lshl_b32 s75, s61, 1
    s_add_u32 s75, s75, s62
    s_sub_u32 s75, s75, 14
    s_lshl_b32 s75, s75, 3
    s_add_u32 s75, s75, s3
    s_add_u32 s75, s75, 4
    s_mul_i32 s75, s75, 13
    v_add_u32 v11, s75, v1
    v_min_u32 v11, 3135, v11
    v_lshlrev_b32 v11, 7, v11
    s_mov_b64 exec, 0x1fff
    global_load_dword v18, v11, s[44:45]
    global_load_dword v18, v11, s[50:51]
    s_mov_b64 exec, -1
L_h_join:
    s_add_u32 s73, s70, 23
    s_add_u32 s74, s71, 23
    s_add_u32 s75, s70, 16
    s_add_u32 s76, s71, 16
    s_add_u32 s77, s70, 21
    s_lshr_b32 s77, s77, 1
    s_add_u32 s78, s71, 21
    s_lshr_b32 s78, s78, 1
    v_mov_b32 v2, s73
    v_cmp_le_u32 vcc, 1, v1
    v_mov_b32 v3, s74
    s_nop 0
    v_cndmask_b32 v2, v2, v3, vcc
    v_cmp_le_u32 vcc, 2, v1
    v_mov_b32 v3, s75
    s_nop 0
    v_cndmask_b32 v2, v2, v3, vcc
    v_cmp_le_u32 vcc, 3, v1
    v_mov_b32 v3, s76
    s_nop 0
    v_cndmask_b32 v2, v2, v3, vcc
    v_cmp_le_u32 vcc, 4, v1
    v_mov_b32 v3, s77
    s_nop 0
    v_cndmask_b32 v2, v2, v3, vcc
    v_cmp_le_u32 vcc, 5, v1
    v_mov_b32 v3, s78
    s_nop 0
    v_cndmask_b32 v2, v2, v3, vcc
    v_cmp_le_u32 vcc, 6, v1
    v_mov_b32 v3, 14
    s_nop 0
    v_cndmask_b32 v2, v2, v3, vcc
    v_cmp_le_u32 vcc, 7, v1
    v_mov_b32 v3, 15
    s_nop 0
    v_cndmask_b32 v2, v2, v3, vcc
    s_lshl_b32 s73, s64, 7
    s_add_u32 s73, s73, 16547840
    v_lshlrev_b32 v2, 11, v2
    v_add_u32 v28, s73, v2
    s_lshl_b32 s73, s63, 17
    s_lshl_b32 s74, s64, 13
    s_add_u32 s73, s73, s74
    s_add_u32 s73, s73, 7602176
    v_lshrrev_b32 v2, 4, v1
    v_and_b32 v3, 15, v1
    v_lshlrev_b32 v3, 4, v3
    v_lshl_add_u32 v2, v2, 9, v3
    s_and_b32 s74, s3, 1
    s_lshl_b32 s74, s74, 8
    s_add_u32 s74, s74, s73
    v_add_u32 v24, s74, v2
    s_lshr_b32 s74, s3, 1
    s_lshl_b32 s74, s74, 8
    s_add_u32 s74, s74, s73
    s_add_u32 s74, s74, 2097152
    v_add_u32 v25, s74, v2
    s_lshl_b32 s73, s63, 15
    s_lshl_b32 s74, s3, 13
    s_add_u32 s73, s73, s74
    s_add_u32 s73, s73, 15990784
    v_and_b32 v2, 15, v1
    v_lshlrev_b32 v2, 5, v2
    v_lshrrev_b32 v3, 4, v1
    v_lshl_add_u32 v4, v3, 3, v2
    s_lshl_b32 s74, s64, 9
    s_add_u32 s74, s74, s73
    v_add_u32 v141, s74, v4
    v_and_b32 v4, 1, v3
    v_lshl_add_u32 v2, v4, 4, v2
    v_lshrrev_b32 v3, 1, v3
    v_lshl_add_u32 v2, v3, 9, v2
    v_add_u32 v23, s73, v2
    v_and_b32 v2, 15, v1
    v_lshlrev_b32 v4, 3, v4
    v_sub_u32 v2, v2, v4
    v_and_b32 v3, 1, v2
    v_lshlrev_b32 v3, 4, v3
    v_mov_b32 v4, 0x3f80
    v_lshlrev_b32 v3, v3, v4
    v_lshrrev_b32 v2, 1, v2
    v_cmp_eq_u32 vcc, 0, v2
    s_nop 1
    v_cndmask_b32 v136, v27, v3, vcc
    v_cmp_eq_u32 vcc, 1, v2
    s_nop 1
    v_cndmask_b32 v137, v27, v3, vcc
    v_cmp_eq_u32 vcc, 2, v2
    s_nop 1
    v_cndmask_b32 v138, v27, v3, vcc
    v_cmp_eq_u32 vcc, 3, v2
    s_nop 1
    v_cndmask_b32 v139, v27, v3, vcc
    s_lshl_b32 s73, s64, 2
    s_add_u32 s73, s73, s3
    s_mul_i32 s73, s73, 86016
    s_lshl_b32 s74, s65, 9
    s_add_u32 s73, s73, s74
    s_add_u32 s73, s73, 57344
    v_add_u32 v22, s73, v0
    s_lshl_b32 s73, s64, 2
    s_add_u32 s73, s73, s3
    s_lshl_b32 s73, s73, 16
    s_lshl_b32 s74, s63, 11
    s_add_u32 s73, s73, s74
    s_add_u32 s73, s73, 11829248
    v_add_u32 v19, s73, v0
    s_mov_b32 s0, 0
    s_mov_b32 s1, -1
    s_lshl_b32 s73, s63, 2
    s_add_u32 s73, s73, s3
    s_lshl_b32 s73, s73, 11
    s_add_u32 s73, s73, 17563648
    v_and_b32 v2, 15, v1
    v_lshlrev_b32 v3, 7, v2
    v_add_u32 v9, s73, v3
    s_lshl_b32 s74, s64, 7
    s_add_u32 s73, s73, s74
    v_mov_b32 v2, 1073741824
    v_mov_b32 v3, s73
    v_cndmask_b32 v20, v2, v3, s[90:91]
    s_lshl_b32 s73, s64, 2
    s_add_u32 s73, s73, s3
    s_lshl_b32 s73, s73, 4
    s_add_u32 s73, s73, s63
    s_lshl_b32 s73, s73, 7
    s_add_u32 s73, s73, 17432576
    v_mov_b32 v3, s73
    v_cndmask_b32 v21, v2, v3, s[90:91]
    s_lshl_b32 s73, s67, 1
    s_and_b32 s74, s3, 1
    s_add_u32 s73, s73, s74
    s_lshr_b32 s74, s3, 1
    s_lshl_b32 s75, s73, 1
    s_add_u32 s75, s75, s74
    s_lshl_b32 s75, s75, 10
    s_add_u32 s75, s75, 17301504
    v_and_b32 v2, 7, v1
    v_lshlrev_b32 v2, 7, v2
    v_add_u32 v140, s75, v2
    s_mul_i32 s75, s73, 65536
    s_mul_i32 s76, s74, 16384
    s_add_u32 s75, s75, s76
    s_add_u32 s75, s75, 11796480
    v_add_u32 v15, s75, v0
    s_mul_i32 s75, s73, 28672
    s_lshl_b32 s76, s68, 7
    s_add_u32 s75, s75, s76
    s_lshl_b32 s76, s74, 6
    s_add_u32 s75, s75, s76
    v_and_b32 v2, 31, v1
    v_mul_u32_u24 v2, 896, v2
    v_lshrrev_b32 v3, 5, v1
    v_lshl_add_u32 v2, v3, 4, v2
    v_add_u32 v14, s75, v2
    v_and_b32 v2, 3, v1
    v_and_b32 v3, 1, v2
    v_lshrrev_b32 v2, 1, v2
    v_lshl_or_b32 v2, v3, 1, v2
    v_bfe_u32 v3, v1, 4, 1
    v_lshl_or_b32 v2, v3, 2, v2
    v_bfe_u32 v3, v1, 2, 2
    v_lshrrev_b32 v5, 5, v1
    v_lshl_add_u32 v3, v5, 3, v3
    v_lshlrev_b32 v3, 7, v3
    v_lshl_add_u32 v3, v2, 3, v3
    v_bfe_u32 v2, v1, 3, 1
    v_lshl_or_b32 v4, v2, 6, v3
    v_xor_b32 v4, s76, v4
    s_mul_i32 s75, s74, 28672
    v_add_u32 v10, s75, v4
    v_xor_b32 v11, 64, v10
    v_add_u32 v12, 57344, v10
    v_add_u32 v13, 57344, v11
    v_lshrrev_b32 v2, 5, v1
    v_lshlrev_b32 v2, 9, v2
    v_sub_u32 v132, v10, v2
    v_sub_u32 v133, v11, v2
    v_sub_u32 v134, v12, v2
    v_sub_u32 v135, v13, v2
    s_lshl_b32 s73, s74, 2
    s_cmp_eq_u32 s66, 0
    s_cselect_b32 s75, 7, 0
    s_sub_u32 s75, s75, s73
    v_lshrrev_b32 v2, 4, v1
    v_cmp_eq_u32 s[86:87], s75, v2
    s_lshl_b32 s73, s73, 8
    s_and_b32 s75, s3, 1
    s_lshl_b32 s75, s75, 8
    s_add_u32 s73, s73, s75
    s_add_u32 s73, s73, 156672
    v_and_b32 v3, 15, v1
    v_lshlrev_b32 v3, 4, v3
    v_and_b32 v4, 1, v2
    v_lshl_add_u32 v3, v4, 9, v3
    v_lshrrev_b32 v4, 1, v2
    v_lshl_add_u32 v3, v4, 3, v3
    v_add_u32 v7, s73, v3
    v_add_u32 v6, 156672, v0
L_spin_5:
    ds_read_b32 v2, v17 offset:60
    s_waitcnt lgkmcnt(0)
    v_readfirstlane_b32 s83, v2
    s_cmp_ge_u32 s83, 4
    s_cbranch_scc1 L_spun_6
    s_sleep 3
    s_sub_u32 s79, s79, 1
    s_cbranch_scc0 L_spin_5
    s_mov_b32 s79, 0
L_spun_6:
    s_setprio 0
    buffer_store_dwordx4 v[32:35], v110, s[20:23], 0 offen offset:0 sc1
    buffer_store_dwordx4 v[36:39], v110, s[20:23], 0 offen offset:1024 sc1
    buffer_store_dwordx4 v[40:43], v111, s[20:23], 0 offen offset:0 sc1
    buffer_store_dwordx4 v[44:47], v111, s[20:23], 0 offen offset:1024 sc1
    s_waitcnt vmcnt(0)
    s_setprio 2
    s_mov_b64 exec, 1
    ds_add_rtn_u32 v2, v17, v16 offset:12
    s_mov_b64 exec, -1
    s_waitcnt lgkmcnt(0)
    v_readfirstlane_b32 s83, v2
    s_cmp_lg_u32 s83, 3
    s_cbranch_scc1 L_nopub_7
    s_add_u32 s73, s97, 16580608
    v_mov_b32 v2, 1073741824
    v_mov_b32 v3, s73
    v_cndmask_b32 v29, v2, v3, s[90:91]
    buffer_store_dword v30, v29, s[20:23], 0 offen sc1
L_nopub_7:
    v_mov_b32 v48, -1
    v_mov_b32 v49, -1
    v_mov_b32 v50, -1
    v_mov_b32 v51, -1
    v_subrev_u32 v52, 32768, v19
    s_setprio 0
    buffer_store_dwordx2 v[48:49], v141, s[20:23], 0 offen sc1
    s_sleep 2
    buffer_store_dwordx4 v[48:51], v19, s[20:23], 0 offen offset:0 sc1
    s_sleep 2
    buffer_store_dwordx4 v[48:51], v19, s[20:23], 0 offen offset:1024 sc1
    s_sleep 2
    buffer_store_dwordx4 v[48:51], v52, s[20:23], 0 offen offset:0 sc1
    s_sleep 2
    buffer_store_dwordx4 v[48:51], v52, s[20:23], 0 offen offset:1024 sc1
    s_waitcnt vmcnt(0)
    s_setprio 2
    s_mov_b64 exec, 1
    ds_add_u32 v17, v16 offset:40
    s_mov_b64 exec, -1
    s_cmp_lg_u32 s3, 0
    s_cbranch_scc1 L_rel_8
L_poll_10:
    buffer_load_dword v4, v28, s[20:23], 0 offen sc1
    s_waitcnt vmcnt(0)
    v_cmp_ne_u32 vcc, s60, v4
    s_cmp_eq_u64 vcc, 0
    s_cbranch_scc1 L_polled_11
    s_sleep 4
    s_sub_u32 s79, s79, 1
    s_cbranch_scc0 L_poll_10
    s_mov_b32 s79, 0
L_polled_11:
    s_mov_b64 exec, 1
    ds_add_u32 v17, v16 offset:36
    s_mov_b64 exec, -1
    s_branch L_reld_9
L_rel_8:
    s_waitcnt vmcnt(0)
L_spin_12:
    ds_read_b32 v2, v17 offset:36
    s_waitcnt lgkmcnt(0)
    v_readfirstlane_b32 s83, v2
    s_cmp_ge_u32 s83, 1
    s_cbranch_scc1 L_spun_13
    s_sleep 3
    s_sub_u32 s79, s79, 1
    s_cbranch_scc0 L_spin_12
    s_mov_b32 s79, 0
L_spun_13:
L_reld_9:
    s_setprio 0
    s_mov_b32 s73, 0
    buffer_load_dwordx4 v[64:67], v25, s[20:23], s73 offen sc1
    buffer_load_dwordx4 v[68:71], v24, s[20:23], s73 offen sc1
    s_mov_b32 s73, 2048
    buffer_load_dwordx4 v[72:75], v25, s[20:23], s73 offen sc1
    buffer_load_dwordx4 v[76:79], v24, s[20:23], s73 offen sc1
    s_mov_b32 s73, 4096
    buffer_load_dwordx4 v[80:83], v25, s[20:23], s73 offen sc1
    buffer_load_dwordx4 v[84:87], v24, s[20:23], s73 offen sc1
    s_mov_b32 s73, 6144
    buffer_load_dwordx4 v[88:91], v25, s[20:23], s73 offen sc1
    buffer_load_dwordx4 v[92:95], v24, s[20:23], s73 offen sc1
    s_waitcnt vmcnt(0)
    s_setprio 2
    v_mov_b32 v28, v9
    v_mfma_f32_16x16x32_bf16 v[96:99], v[64:67], v[68:71], 0
    v_mfma_f32_16x16x32_bf16 v[96:99], v[72:75], v[76:79], v[96:99]
    v_mfma_f32_16x16x32_bf16 v[96:99], v[80:83], v[84:87], v[96:99]
    v_mfma_f32_16x16x32_bf16 v[96:99], v[88:91], v[92:95], v[96:99]
    s_nop 7
    v_cvt_pk_bf16_f32 v96, v96, v97
    v_cvt_pk_bf16_f32 v97, v98, v99
    v_cndmask_b32 v96, v96, v27, s[86:87]
    v_cndmask_b32 v97, v97, v27, s[86:87]
    v_min_u32 v96, -2, v96
    buffer_store_dwordx2 v[96:97], v141, s[20:23], 0 offen sc1
    buffer_store_dword v30, v20, s[20:23], 0 offen sc1
    s_setprio 0
    buffer_load_dwordx4 v[56:59], v22, s[20:23], 0 offen offset:0 sc1
    buffer_load_dwordx4 v[60:63], v22, s[20:23], 0 offen offset:1024 sc1
    s_lshl_b32 s73, s64, 2
    s_add_u32 s73, s73, s3
    s_lshl_b32 s73, s73, 7
    s_add_u32 s73, s73, 16515072
    v_and_b32 v2, 31, v1
    v_lshlrev_b32 v2, 2, v2
    buffer_load_dword v18, v2, s[20:23], s73 offen sc1
    s_setprio 2
L_spin_14:
    ds_read_b32 v2, v17 offset:8
    s_waitcnt lgkmcnt(0)
    v_readfirstlane_b32 s83, v2
    s_cmp_ge_u32 s83, 8
    s_cbranch_scc1 L_spun_15
    s_sleep 1
    s_sub_u32 s79, s79, 1
    s_cbranch_scc0 L_spin_14
    s_mov_b32 s79, 0
L_spun_15:
    s_mul_i32 s75, s3, 14336
    s_mul_i32 s76, s3, 100352
    s_setprio 0
    s_add_u32 m0, s75, 0
    s_add_u32 s74, s76, 0
    buffer_load_dwordx4 v26, s[32:35], s74 offen lds
    s_sleep 1
    s_add_u32 m0, s75, 1024
    s_add_u32 s74, s76, 7168
    buffer_load_dwordx4 v26, s[32:35], s74 offen lds
    s_sleep 1
    s_add_u32 m0, s75, 2048
    s_add_u32 s74, s76, 14336
    buffer_load_dwordx4 v26, s[32:35], s74 offen lds
    s_sleep 1
    s_add_u32 m0, s75, 3072
    s_add_u32 s74, s76, 21504
    buffer_load_dwordx4 v26, s[32:35], s74 offen lds
    s_sleep 1
    s_add_u32 m0, s75, 4096
    s_add_u32 s74, s76, 28672
    buffer_load_dwordx4 v26, s[32:35], s74 offen lds
    s_sleep 1
    s_add_u32 m0, s75, 5120
    s_add_u32 s74, s76, 35840
    buffer_load_dwordx4 v26, s[32:35], s74 offen lds
    s_sleep 1
    s_add_u32 m0, s75, 6144
    s_add_u32 s74, s76, 43008
    buffer_load_dwordx4 v26, s[32:35], s74 offen lds
    s_sleep 1
    s_add_u32 m0, s75, 7168
    s_add_u32 s74, s76, 50176
    buffer_load_dwordx4 v26, s[32:35], s74 offen lds
    s_sleep 1
    s_add_u32 m0, s75, 8192
    s_add_u32 s74, s76, 57344
    buffer_load_dwordx4 v26, s[32:35], s74 offen lds
    s_sleep 1
    s_add_u32 m0, s75, 9216
    s_add_u32 s74, s76, 64512
    buffer_load_dwordx4 v26, s[32:35], s74 offen lds
    s_sleep 1
    s_add_u32 m0, s75, 10240
    s_add_u32 s74, s76, 71680
    buffer_load_dwordx4 v26, s[32:35], s74 offen lds
    s_sleep 1
    s_add_u32 m0, s75, 11264
    s_add_u32 s74, s76, 78848
    buffer_load_dwordx4 v26, s[32:35], s74 offen lds
    s_sleep 1
    s_add_u32 m0, s75, 12288
    s_add_u32 s74, s76, 86016
    buffer_load_dwordx4 v26, s[32:35], s74 offen lds
    s_sleep 1
    s_add_u32 m0, s75, 13312
    s_add_u32 s74, s76, 93184
    buffer_load_dwordx4 v26, s[32:35], s74 offen lds
    s_sleep 1
    s_setprio 2
    s_waitcnt vmcnt(0)
    s_mov_b64 exec, 1
    ds_add_u32 v17, v16 offset:56
    s_mov_b64 exec, -1
L_poll_16:
    buffer_load_dword v4, v28, s[20:23], 0 offen sc1
    s_waitcnt vmcnt(0)
    v_cmp_ne_u32 vcc, s60, v4
    s_cmp_eq_u64 vcc, 0
    s_cbranch_scc1 L_polled_17
    s_sleep 4
    s_sub_u32 s79, s79, 1
    s_cbranch_scc0 L_poll_16
    s_mov_b32 s79, 0
L_polled_17:
L_b2:
    s_setprio 0
    s_mov_b32 s73, 0
    buffer_load_dwordx4 v[72:75], v23, s[20:23], s73 offen offset:0 sc1
    buffer_load_dwordx4 v[76:79], v23, s[20:23], s73 offen offset:1024 sc1
    buffer_load_dwordx4 v[80:83], v23, s[20:23], s73 offen offset:2048 sc1
    buffer_load_dwordx4 v[84:87], v23, s[20:23], s73 offen offset:3072 sc1
    s_mov_b32 s73, 4096
    buffer_load_dwordx4 v[88:91], v23, s[20:23], s73 offen offset:0 sc1
    buffer_load_dwordx4 v[92:95], v23, s[20:23], s73 offen offset:1024 sc1
    buffer_load_dwordx4 v[96:99], v23, s[20:23], s73 offen offset:2048 sc1
    buffer_load_dwordx4 v[100:103], v23, s[20:23], s73 offen offset:3072 sc1
    s_waitcnt vmcnt(0)
    s_setprio 2
    v_max_u32 v5, v72, v74
    v_max3_u32 v5, v5, v76, v78
    v_max3_u32 v5, v5, v80, v82
    v_max3_u32 v5, v5, v84, v86
    v_max3_u32 v5, v5, v88, v90
    v_max3_u32 v5, v5, v92, v94
    v_max3_u32 v5, v5, v96, v98
    v_max3_u32 v5, v5, v100, v102
    v_cmp_eq_u32 vcc, -1, v5
    s_cmp_eq_u64 vcc, 0
    s_cbranch_scc1 L_ok_18
    s_sub_u32 s79, s79, 1
    s_cbranch_scc0 L_b2
    s_mov_b32 s79, 0
L_ok_18:
    v_add_u32 v28, 131072, v140
    v_mfma_f32_16x16x32_bf16 v[64:67], v[136:139], v[72:75], 0
    v_mfma_f32_16x16x32_bf16 v[64:67], v[136:139], v[76:79], v[64:67]
    v_mfma_f32_16x16x32_bf16 v[64:67], v[136:139], v[80:83], v[64:67]
    v_mfma_f32_16x16x32_bf16 v[64:67], v[136:139], v[84:87], v[64:67]
    v_mfma_f32_16x16x32_bf16 v[64:67], v[136:139], v[88:91], v[64:67]
    v_mfma_f32_16x16x32_bf16 v[64:67], v[136:139], v[92:95], v[64:67]
    v_mfma_f32_16x16x32_bf16 v[64:67], v[136:139], v[96:99], v[64:67]
    v_mfma_f32_16x16x32_bf16 v[64:67], v[136:139], v[100:103], v[64:67]
    s_nop 7
    v_cvt_pk_bf16_f32 v4, v64, v65
    v_cvt_pk_bf16_f32 v5, v66, v67
    ds_write_b64 v7, v[4:5]
    s_mov_b64 exec, 1
    ds_add_u32 v17, v16 offset:28
    s_mov_b64 exec, -1
L_spin_19:
    ds_read_b32 v2, v17 offset:28
    s_waitcnt lgkmcnt(0)
    v_readfirstlane_b32 s83, v2
    s_cmp_ge_u32 s83, 4
    s_cbranch_scc1 L_spun_20
    s_sleep 1
    s_sub_u32 s79, s79, 1
    s_cbranch_scc0 L_spin_19
    s_mov_b32 s79, 0
L_spun_20:
    ds_read_b128 v[64:67], v6
    ds_read_b128 v[68:71], v6 offset:1024
    s_waitcnt lgkmcnt(0)
    v_mfma_f32_32x32x16_bf16 v[80:95], v[64:67], v[56:59], 0
    v_mfma_f32_32x32x16_bf16 v[80:95], v[68:71], v[60:63], v[80:95]
    v_sub_f32 v4, 1.0, v18
    s_nop 10
    v_mov_b32 v3, v92
    v_mov_b32 v2, v92
    s_nop 1
    v_permlane32_swap_b32 v3, v2
    v_add_f32 v2, 0x358637bd, v2
    v_rcp_f32 v2, v2
    s_nop 0
    v_mul_f32 v2, v2, v4
    v_mul_f32 v80, v2, v80
    v_mul_f32 v81, v2, v81
    v_mul_f32 v82, v2, v82
    v_mul_f32 v83, v2, v83
    v_mul_f32 v84, v2, v84
    v_mul_f32 v85, v2, v85
    v_mul_f32 v86, v2, v86
    v_mul_f32 v87, v2, v87
    v_mul_f32 v88, v2, v88
    v_mul_f32 v89, v2, v89
    v_mul_f32 v90, v2, v90
    v_mul_f32 v91, v2, v91
    v_mul_f32 v92, v2, v92
    v_mul_f32 v93, v2, v93
    v_mul_f32 v94, v2, v94
    v_mul_f32 v95, v2, v95
    v_cvt_pk_bf16_f32 v64, v80, v81
    v_cvt_pk_bf16_f32 v65, v82, v83
    v_cvt_pk_bf16_f32 v66, v84, v85
    v_cvt_pk_bf16_f32 v67, v86, v87
    v_cvt_pk_bf16_f32 v68, v88, v89
    v_cvt_pk_bf16_f32 v69, v90, v91
    v_cvt_pk_bf16_f32 v70, v92, v93
    v_cvt_pk_bf16_f32 v71, v94, v95
    v_min_u32 v64, -2, v64
    v_min_u32 v68, -2, v68
    v_cndmask_b32 v70, v70, v27, s[0:1]
    buffer_store_dwordx4 v[64:67], v19, s[20:23], 0 offen offset:0 sc1
    buffer_store_dwordx4 v[68:71], v19, s[20:23], 0 offen offset:1024 sc1
    buffer_store_dword v30, v21, s[20:23], 0 offen sc1
    s_cmp_eq_u32 s69, 0
    s_cbranch_scc1 L_fin
L_spin_21:
    ds_read_b32 v2, v17 offset:8
    s_waitcnt lgkmcnt(0)
    v_readfirstlane_b32 s83, v2
    s_cmp_ge_u32 s83, 8
    s_cbranch_scc1 L_spun_22
    s_sleep 1
    s_sub_u32 s79, s79, 1
    s_cbranch_scc0 L_spin_21
    s_mov_b32 s79, 0
L_spun_22:
    s_mul_i32 s75, s3, 12288
    s_mul_i32 s76, s3, 86016
    s_setprio 0
    s_add_u32 m0, s75, 57344
    s_add_u32 s74, s76, 0
    buffer_load_dwordx4 v26, s[28:31], s74 offen lds
    s_sleep 1
    s_add_u32 m0, s75, 58368
    s_add_u32 s74, s76, 7168
    buffer_load_dwordx4 v26, s[28:31], s74 offen lds
    s_sleep 1
    s_add_u32 m0, s75, 59392
    s_add_u32 s74, s76, 14336
    buffer_load_dwordx4 v26, s[28:31], s74 offen lds
    s_sleep 1
    s_add_u32 m0, s75, 60416
    s_add_u32 s74, s76, 21504
    buffer_load_dwordx4 v26, s[28:31], s74 offen lds
    s_sleep 1
    s_add_u32 m0, s75, 61440
    s_add_u32 s74, s76, 28672
    buffer_load_dwordx4 v26, s[28:31], s74 offen lds
    s_sleep 1
    s_add_u32 m0, s75, 62464
    s_add_u32 s74, s76, 35840
    buffer_load_dwordx4 v26, s[28:31], s74 offen lds
    s_sleep 1
    s_add_u32 m0, s75, 63488
    s_add_u32 s74, s76, 43008
    buffer_load_dwordx4 v26, s[28:31], s74 offen lds
    s_sleep 1
    s_add_u32 m0, s75, 64512
    s_add_u32 s74, s76, 50176
    buffer_load_dwordx4 v26, s[28:31], s74 offen lds
    s_sleep 1
    s_add_u32 m0, s75, 65536
    s_add_u32 s74, s76, 57344
    buffer_load_dwordx4 v26, s[28:31], s74 offen lds
    s_sleep 1
    s_add_u32 m0, s75, 66560
    s_add_u32 s74, s76, 64512
    buffer_load_dwordx4 v26, s[28:31], s74 offen lds
    s_sleep 1
    s_add_u32 m0, s75, 67584
    s_add_u32 s74, s76, 71680
    buffer_load_dwordx4 v26, s[28:31], s74 offen lds
    s_sleep 1
    s_add_u32 m0, s75, 68608
    s_add_u32 s74, s76, 78848
    buffer_load_dwordx4 v26, s[28:31], s74 offen lds
    s_sleep 1
    s_setprio 2
L_poll_23:
    buffer_load_dword v4, v28, s[20:23], 0 offen sc1
    s_waitcnt vmcnt(0)
    v_cmp_ne_u32 vcc, s60, v4
    s_cmp_eq_u64 vcc, 0
    s_cbranch_scc1 L_polled_24
    s_sleep 4
    s_sub_u32 s79, s79, 1
    s_cbranch_scc0 L_poll_23
    s_mov_b32 s79, 0
L_polled_24:
L_ob:
    s_setprio 0
    s_mov_b32 s73, 32768
    buffer_load_dwordx4 v[64:67], v15, s[20:23], s73 offen offset:0 sc1
    buffer_load_dwordx4 v[68:71], v15, s[20:23], s73 offen offset:1024 sc1
    buffer_load_dwordx4 v[72:75], v15, s[20:23], s73 offen offset:2048 sc1
    buffer_load_dwordx4 v[76:79], v15, s[20:23], s73 offen offset:3072 sc1
    s_mov_b32 s73, 36864
    buffer_load_dwordx4 v[80:83], v15, s[20:23], s73 offen offset:0 sc1
    buffer_load_dwordx4 v[84:87], v15, s[20:23], s73 offen offset:1024 sc1
    buffer_load_dwordx4 v[88:91], v15, s[20:23], s73 offen offset:2048 sc1
    buffer_load_dwordx4 v[92:95], v15, s[20:23], s73 offen offset:3072 sc1
    s_mov_b32 s73, 40960
    buffer_load_dwordx4 v[96:99], v15, s[20:23], s73 offen offset:0 sc1
    buffer_load_dwordx4 v[100:103], v15, s[20:23], s73 offen offset:1024 sc1
    buffer_load_dwordx4 v[104:107], v15, s[20:23], s73 offen offset:2048 sc1
    buffer_load_dwordx4 v[108:111], v15, s[20:23], s73 offen offset:3072 sc1
    s_mov_b32 s73, 45056
    buffer_load_dwordx4 v[112:115], v15, s[20:23], s73 offen offset:0 sc1
    buffer_load_dwordx4 v[116:119], v15, s[20:23], s73 offen offset:1024 sc1
    buffer_load_dwordx4 v[120:123], v15, s[20:23], s73 offen offset:2048 sc1
    buffer_load_dwordx4 v[124:127], v15, s[20:23], s73 offen offset:3072 sc1
    s_waitcnt vmcnt(0)
    s_setprio 2
    v_max_u32 v5, v64, v68
    v_max3_u32 v5, v5, v72, v76
    v_max3_u32 v5, v5, v80, v84
    v_max3_u32 v5, v5, v88, v92
    v_max3_u32 v5, v5, v96, v100
    v_max3_u32 v5, v5, v104, v108
    v_max3_u32 v5, v5, v112, v116
    v_max3_u32 v5, v5, v120, v124
    v_cmp_eq_u32 vcc, -1, v5
    s_cmp_eq_u64 vcc, 0
    s_cbranch_scc1 L_ok_25
    s_sub_u32 s79, s79, 1
    s_cbranch_scc0 L_ob
    s_mov_b32 s79, 0
L_ok_25:
    v_mov_b32 v28, v140
    s_xor_b32 s73, s3, 2
    s_lshl_b32 s73, s73, 12
    s_add_u32 s73, s73, 114688
    v_add_u32 v6, s73, v0
    s_lshl_b32 s73, s3, 12
    s_add_u32 s73, s73, 114688
    v_add_u32 v7, s73, v0
L_spin_26:
    ds_read_b32 v2, v17 offset:20
    s_waitcnt lgkmcnt(0)
    v_readfirstlane_b32 s83, v2
    s_cmp_ge_u32 s83, 4
    s_cbranch_scc1 L_spun_27
    s_sleep 3
    s_sub_u32 s79, s79, 1
    s_cbranch_scc0 L_spin_26
    s_mov_b32 s79, 0
L_spun_27:
    s_mul_i32 s75, s3, 2048
    s_mul_i32 s76, s3, 14336
    s_add_u32 m0, s75, 106496
    s_add_u32 s74, s76, 344064
    buffer_load_dwordx4 v26, s[28:31], s74 offen lds
    s_add_u32 m0, s75, 107520
    s_add_u32 s74, s76, 351232
    buffer_load_dwordx4 v26, s[28:31], s74 offen lds
L_spin_28:
    ds_read_b32 v2, v17 offset:56
    s_waitcnt lgkmcnt(0)
    v_readfirstlane_b32 s83, v2
    s_cmp_ge_u32 s83, 4
    s_cbranch_scc1 L_spun_29
    s_sleep 1
    s_sub_u32 s79, s79, 1
    s_cbranch_scc0 L_spin_28
    s_mov_b32 s79, 0
L_spun_29:
    ds_read_b64_tr_b16 v[176:177], v10 offset:0
    ds_read_b64_tr_b16 v[178:179], v10 offset:512
    ds_read_b64_tr_b16 v[180:181], v11 offset:0
    ds_read_b64_tr_b16 v[182:183], v11 offset:512
    ds_read_b64_tr_b16 v[184:185], v10 offset:2048
    ds_read_b64_tr_b16 v[186:187], v132 offset:2560
    ds_read_b64_tr_b16 v[188:189], v11 offset:2048
    ds_read_b64_tr_b16 v[190:191], v133 offset:2560
    s_waitcnt lgkmcnt(4)
    v_mfma_f32_32x32x16_bf16 v[32:47], v[176:179], v[64:67], 0
    ds_read_b64_tr_b16 v[192:193], v10 offset:3584
    ds_read_b64_tr_b16 v[194:195], v10 offset:4096
    ds_read_b64_tr_b16 v[196:197], v11 offset:3584
    ds_read_b64_tr_b16 v[198:199], v11 offset:4096
    v_mfma_f32_32x32x16_bf16 v[48:63], v[180:183], v[64:67], 0
    s_waitcnt lgkmcnt(4)
    v_mfma_f32_32x32x16_bf16 v[32:47], v[184:187], v[68:71], v[32:47]
    ds_read_b64_tr_b16 v[176:177], v10 offset:5632
    ds_read_b64_tr_b16 v[178:179], v132 offset:6144
    ds_read_b64_tr_b16 v[180:181], v11 offset:5632
    ds_read_b64_tr_b16 v[182:183], v133 offset:6144
    v_mfma_f32_32x32x16_bf16 v[48:63], v[188:191], v[68:71], v[48:63]
    s_waitcnt lgkmcnt(4)
    v_mfma_f32_32x32x16_bf16 v[32:47], v[192:195], v[72:75], v[32:47]
    ds_read_b64_tr_b16 v[184:185], v10 offset:7168
    ds_read_b64_tr_b16 v[186:187], v10 offset:7680
    ds_read_b64_tr_b16 v[188:189], v11 offset:7168
    ds_read_b64_tr_b16 v[190:191], v11 offset:7680
    v_mfma_f32_32x32x16_bf16 v[48:63], v[196:199], v[72:75], v[48:63]
    s_waitcnt lgkmcnt(4)
    v_mfma_f32_32x32x16_bf16 v[32:47], v[176:179], v[76:79], v[32:47]
    ds_read_b64_tr_b16 v[192:193], v10 offset:9216
    ds_read_b64_tr_b16 v[194:195], v132 offset:9728
    ds_read_b64_tr_b16 v[196:197], v11 offset:9216
    ds_read_b64_tr_b16 v[198:199], v133 offset:9728
    v_mfma_f32_32x32x16_bf16 v[48:63], v[180:183], v[76:79], v[48:63]
    s_waitcnt lgkmcnt(4)
    v_mfma_f32_32x32x16_bf16 v[32:47], v[184:187], v[80:83], v[32:47]
    ds_read_b64_tr_b16 v[176:177], v10 offset:10752
    ds_read_b64_tr_b16 v[178:179], v10 offset:11264
    ds_read_b64_tr_b16 v[180:181], v11 offset:10752
    ds_read_b64_tr_b16 v[182:183], v11 offset:11264
    v_mfma_f32_32x32x16_bf16 v[48:63], v[188:191], v[80:83], v[48:63]
    s_waitcnt lgkmcnt(4)
    v_mfma_f32_32x32x16_bf16 v[32:47], v[192:195], v[84:87], v[32:47]
    ds_read_b64_tr_b16 v[184:185], v10 offset:12800
    ds_read_b64_tr_b16 v[186:187], v132 offset:13312
    ds_read_b64_tr_b16 v[188:189], v11 offset:12800
    ds_read_b64_tr_b16 v[190:191], v133 offset:13312
    v_mfma_f32_32x32x16_bf16 v[48:63], v[196:199], v[84:87], v[48:63]
    s_waitcnt lgkmcnt(4)
    v_mfma_f32_32x32x16_bf16 v[32:47], v[176:179], v[88:91], v[32:47]
    ds_read_b64_tr_b16 v[192:193], v10 offset:14336
    ds_read_b64_tr_b16 v[194:195], v10 offset:14848
    ds_read_b64_tr_b16 v[196:197], v11 offset:14336
    ds_read_b64_tr_b16 v[198:199], v11 offset:14848
    v_mfma_f32_32x32x16_bf16 v[48:63], v[180:183], v[88:91], v[48:63]
    s_waitcnt lgkmcnt(4)
    v_mfma_f32_32x32x16_bf16 v[32:47], v[184:187], v[92:95], v[32:47]
    ds_read_b64_tr_b16 v[176:177], v10 offset:16384
    ds_read_b64_tr_b16 v[178:179], v132 offset:16896
    ds_read_b64_tr_b16 v[180:181], v11 offset:16384
    ds_read_b64_tr_b16 v[182:183], v133 offset:16896
    v_mfma_f32_32x32x16_bf16 v[48:63], v[188:191], v[92:95], v[48:63]
    s_waitcnt lgkmcnt(4)
    v_mfma_f32_32x32x16_bf16 v[32:47], v[192:195], v[96:99], v[32:47]
    ds_read_b64_tr_b16 v[184:185], v10 offset:17920
    ds_read_b64_tr_b16 v[186:187], v10 offset:18432
    ds_read_b64_tr_b16 v[188:189], v11 offset:17920
    ds_read_b64_tr_b16 v[190:191], v11 offset:18432
    v_mfma_f32_32x32x16_bf16 v[48:63], v[196:199], v[96:99], v[48:63]
    s_waitcnt lgkmcnt(4)
    v_mfma_f32_32x32x16_bf16 v[32:47], v[176:179], v[100:103], v[32:47]
    ds_read_b64_tr_b16 v[192:193], v10 offset:19968
    ds_read_b64_tr_b16 v[194:195], v132 offset:20480
    ds_read_b64_tr_b16 v[196:197], v11 offset:19968
    ds_read_b64_tr_b16 v[198:199], v133 offset:20480
    v_mfma_f32_32x32x16_bf16 v[48:63], v[180:183], v[100:103], v[48:63]
    s_waitcnt lgkmcnt(4)
    v_mfma_f32_32x32x16_bf16 v[32:47], v[184:187], v[104:107], v[32:47]
    ds_read_b64_tr_b16 v[176:177], v10 offset:21504
    ds_read_b64_tr_b16 v[178:179], v10 offset:22016
    ds_read_b64_tr_b16 v[180:181], v11 offset:21504
    ds_read_b64_tr_b16 v[182:183], v11 offset:22016
    v_mfma_f32_32x32x16_bf16 v[48:63], v[188:191], v[104:107], v[48:63]
    s_waitcnt lgkmcnt(4)
    v_mfma_f32_32x32x16_bf16 v[32:47], v[192:195], v[108:111], v[32:47]
    ds_read_b64_tr_b16 v[184:185], v10 offset:23552
    ds_read_b64_tr_b16 v[186:187], v132 offset:24064
    ds_read_b64_tr_b16 v[188:189], v11 offset:23552
    ds_read_b64_tr_b16 v[190:191], v133 offset:24064
    v_mfma_f32_32x32x16_bf16 v[48:63], v[196:199], v[108:111], v[48:63]
    s_waitcnt lgkmcnt(4)
    v_mfma_f32_32x32x16_bf16 v[32:47], v[176:179], v[112:115], v[32:47]
    ds_read_b64_tr_b16 v[192:193], v10 offset:25088
    ds_read_b64_tr_b16 v[194:195], v10 offset:25600
    ds_read_b64_tr_b16 v[196:197], v11 offset:25088
    ds_read_b64_tr_b16 v[198:199], v11 offset:25600
    v_mfma_f32_32x32x16_bf16 v[48:63], v[180:183], v[112:115], v[48:63]
    s_waitcnt lgkmcnt(4)
    v_mfma_f32_32x32x16_bf16 v[32:47], v[184:187], v[116:119], v[32:47]
    ds_read_b64_tr_b16 v[176:177], v10 offset:27136
    ds_read_b64_tr_b16 v[178:179], v132 offset:27648
    ds_read_b64_tr_b16 v[180:181], v11 offset:27136
    ds_read_b64_tr_b16 v[182:183], v133 offset:27648
    v_mfma_f32_32x32x16_bf16 v[48:63], v[188:191], v[116:119], v[48:63]
    s_waitcnt lgkmcnt(4)
    v_mfma_f32_32x32x16_bf16 v[32:47], v[192:195], v[120:123], v[32:47]
    v_mfma_f32_32x32x16_bf16 v[48:63], v[196:199], v[120:123], v[48:63]
    s_waitcnt lgkmcnt(0)
    v_mfma_f32_32x32x16_bf16 v[32:47], v[176:179], v[124:127], v[32:47]
    v_mfma_f32_32x32x16_bf16 v[48:63], v[180:183], v[124:127], v[48:63]
L_poll_30:
    buffer_load_dword v4, v28, s[20:23], 0 offen sc1
    s_waitcnt vmcnt(0)
    v_cmp_ne_u32 vcc, s60, v4
    s_cmp_eq_u64 vcc, 0
    s_cbranch_scc1 L_polled_31
    s_sleep 2
    s_sub_u32 s79, s79, 1
    s_cbranch_scc0 L_poll_30
    s_mov_b32 s79, 0
L_polled_31:
    s_mov_b64 exec, 1
    ds_add_u32 v17, v16 offset:16
    s_mov_b64 exec, -1
L_p3a:
    s_mov_b32 s73, 0
    buffer_load_dwordx4 v[64:67], v15, s[20:23], s73 offen offset:0 sc1
    buffer_load_dwordx4 v[68:71], v15, s[20:23], s73 offen offset:1024 sc1
    buffer_load_dwordx4 v[72:75], v15, s[20:23], s73 offen offset:2048 sc1
    buffer_load_dwordx4 v[76:79], v15, s[20:23], s73 offen offset:3072 sc1
    s_mov_b32 s73, 4096
    buffer_load_dwordx4 v[80:83], v15, s[20:23], s73 offen offset:0 sc1
    buffer_load_dwordx4 v[84:87], v15, s[20:23], s73 offen offset:1024 sc1
    buffer_load_dwordx4 v[88:91], v15, s[20:23], s73 offen offset:2048 sc1
    buffer_load_dwordx4 v[92:95], v15, s[20:23], s73 offen offset:3072 sc1
    s_mov_b32 s73, 8192
    buffer_load_dwordx4 v[96:99], v15, s[20:23], s73 offen offset:0 sc1
    buffer_load_dwordx4 v[100:103], v15, s[20:23], s73 offen offset:1024 sc1
    buffer_load_dwordx4 v[104:107], v15, s[20:23], s73 offen offset:2048 sc1
    buffer_load_dwordx4 v[108:111], v15, s[20:23], s73 offen offset:3072 sc1
    s_mov_b32 s73, 12288
    buffer_load_dwordx4 v[112:115], v15, s[20:23], s73 offen offset:0 sc1
    buffer_load_dwordx4 v[116:119], v15, s[20:23], s73 offen offset:1024 sc1
    buffer_load_dwordx4 v[120:123], v15, s[20:23], s73 offen offset:2048 sc1
    buffer_load_dwordx4 v[124:127], v15, s[20:23], s73 offen offset:3072 sc1
L_spin_32:
    ds_read_b32 v2, v17 offset:16
    s_waitcnt lgkmcnt(0)
    v_readfirstlane_b32 s83, v2
    s_cmp_ge_u32 s83, 4
    s_cbranch_scc1 L_spun_33
    s_sub_u32 s79, s79, 1
    s_cbranch_scc0 L_spin_32
    s_mov_b32 s79, 0
L_spun_33:
    ds_read_b64_tr_b16 v[176:177], v12 offset:0
    ds_read_b64_tr_b16 v[178:179], v12 offset:512
    ds_read_b64_tr_b16 v[180:181], v13 offset:0
    ds_read_b64_tr_b16 v[182:183], v13 offset:512
    ds_read_b64_tr_b16 v[184:185], v12 offset:2048
    ds_read_b64_tr_b16 v[186:187], v134 offset:2560
    ds_read_b64_tr_b16 v[188:189], v13 offset:2048
    ds_read_b64_tr_b16 v[190:191], v135 offset:2560
    v_mov_b32 v5, 0
    s_waitcnt vmcnt(15)
    s_waitcnt lgkmcnt(4)
    v_mfma_f32_32x32x16_bf16 v[160:175], v[180:183], v[64:67], v[48:63]
    ds_read_b64_tr_b16 v[192:193], v12 offset:3584
    ds_read_b64_tr_b16 v[194:195], v12 offset:4096
    ds_read_b64_tr_b16 v[196:197], v13 offset:3584
    ds_read_b64_tr_b16 v[198:199], v13 offset:4096
    v_mfma_f32_32x32x16_bf16 v[144:159], v[176:179], v[64:67], v[32:47]
    s_waitcnt vmcnt(14)
    s_waitcnt lgkmcnt(4)
    v_mfma_f32_32x32x16_bf16 v[160:175], v[188:191], v[68:71], v[160:175]
    ds_read_b64_tr_b16 v[176:177], v12 offset:5632
    ds_read_b64_tr_b16 v[178:179], v134 offset:6144
    ds_read_b64_tr_b16 v[180:181], v13 offset:5632
    ds_read_b64_tr_b16 v[182:183], v135 offset:6144
    v_mfma_f32_32x32x16_bf16 v[144:159], v[184:187], v[68:71], v[144:159]
    v_max3_u32 v5, v5, v64, v68
    s_waitcnt vmcnt(13)
    s_waitcnt lgkmcnt(4)
    v_mfma_f32_32x32x16_bf16 v[160:175], v[196:199], v[72:75], v[160:175]
    ds_read_b64_tr_b16 v[184:185], v12 offset:7168
    ds_read_b64_tr_b16 v[186:187], v12 offset:7680
    ds_read_b64_tr_b16 v[188:189], v13 offset:7168
    ds_read_b64_tr_b16 v[190:191], v13 offset:7680
    v_mfma_f32_32x32x16_bf16 v[144:159], v[192:195], v[72:75], v[144:159]
    s_waitcnt vmcnt(12)
    s_waitcnt lgkmcnt(4)
    v_mfma_f32_32x32x16_bf16 v[160:175], v[180:183], v[76:79], v[160:175]
    ds_read_b64_tr_b16 v[192:193], v12 offset:9216
    ds_read_b64_tr_b16 v[194:195], v134 offset:9728
    ds_read_b64_tr_b16 v[196:197], v13 offset:9216
    ds_read_b64_tr_b16 v[198:199], v135 offset:9728
    v_mfma_f32_32x32x16_bf16 v[144:159], v[176:179], v[76:79], v[144:159]
    v_max3_u32 v5, v5, v72, v76
    s_waitcnt vmcnt(11)
    s_waitcnt lgkmcnt(4)
    v_mfma_f32_32x32x16_bf16 v[160:175], v[188:191], v[80:83], v[160:175]
    ds_read_b64_tr_b16 v[176:177], v12 offset:10752
    ds_read_b64_tr_b16 v[178:179], v12 offset:11264
    ds_read_b64_tr_b16 v[180:181], v13 offset:10752
    ds_read_b64_tr_b16 v[182:183], v13 offset:11264
    v_mfma_f32_32x32x16_bf16 v[144:159], v[184:187], v[80:83], v[144:159]
    s_waitcnt vmcnt(10)
    s_waitcnt lgkmcnt(4)
    v_mfma_f32_32x32x16_bf16 v[160:175], v[196:199], v[84:87], v[160:175]
    ds_read_b64_tr_b16 v[184:185], v12 offset:12800
    ds_read_b64_tr_b16 v[186:187], v134 offset:13312
    ds_read_b64_tr_b16 v[188:189], v13 offset:12800
    ds_read_b64_tr_b16 v[190:191], v135 offset:13312
    v_mfma_f32_32x32x16_bf16 v[144:159], v[192:195], v[84:87], v[144:159]
    v_max3_u32 v5, v5, v80, v84
    s_waitcnt vmcnt(9)
    s_waitcnt lgkmcnt(4)
    v_mfma_f32_32x32x16_bf16 v[160:175], v[180:183], v[88:91], v[160:175]
    ds_read_b64_tr_b16 v[192:193], v12 offset:14336
    ds_read_b64_tr_b16 v[194:195], v12 offset:14848
    ds_read_b64_tr_b16 v[196:197], v13 offset:14336
    ds_read_b64_tr_b16 v[198:199], v13 offset:14848
    v_mfma_f32_32x32x16_bf16 v[144:159], v[176:179], v[88:91], v[144:159]
    s_waitcnt vmcnt(8)
    s_waitcnt lgkmcnt(4)
    v_mfma_f32_32x32x16_bf16 v[160:175], v[188:191], v[92:95], v[160:175]
    ds_read_b64_tr_b16 v[176:177], v12 offset:16384
    ds_read_b64_tr_b16 v[178:179], v134 offset:16896
    ds_read_b64_tr_b16 v[180:181], v13 offset:16384
    ds_read_b64_tr_b16 v[182:183], v135 offset:16896
    v_mfma_f32_32x32x16_bf16 v[144:159], v[184:187], v[92:95], v[144:159]
    v_max3_u32 v5, v5, v88, v92
    s_waitcnt vmcnt(7)
    s_waitcnt lgkmcnt(4)
    v_mfma_f32_32x32x16_bf16 v[160:175], v[196:199], v[96:99], v[160:175]
    ds_read_b64_tr_b16 v[184:185], v12 offset:17920
    ds_read_b64_tr_b16 v[186:187], v12 offset:18432
    ds_read_b64_tr_b16 v[188:189], v13 offset:17920
    ds_read_b64_tr_b16 v[190:191], v13 offset:18432
    v_mfma_f32_32x32x16_bf16 v[144:159], v[192:195], v[96:99], v[144:159]
    s_waitcnt vmcnt(6)
    s_waitcnt lgkmcnt(4)
    v_mfma_f32_32x32x16_bf16 v[160:175], v[180:183], v[100:103], v[160:175]
    ds_read_b64_tr_b16 v[192:193], v12 offset:19968
    ds_read_b64_tr_b16 v[194:195], v134 offset:20480
    ds_read_b64_tr_b16 v[196:197], v13 offset:19968
    ds_read_b64_tr_b16 v[198:199], v135 offset:20480
    v_mfma_f32_32x32x16_bf16 v[144:159], v[176:179], v[100:103], v[144:159]
    v_max3_u32 v5, v5, v96, v100
    s_waitcnt vmcnt(5)
    s_waitcnt lgkmcnt(4)
    v_mfma_f32_32x32x16_bf16 v[160:175], v[188:191], v[104:107], v[160:175]
    ds_read_b64_tr_b16 v[176:177], v12 offset:21504
    ds_read_b64_tr_b16 v[178:179], v12 offset:22016
    ds_read_b64_tr_b16 v[180:181], v13 offset:21504
    ds_read_b64_tr_b16 v[182:183], v13 offset:22016
    v_mfma_f32_32x32x16_bf16 v[144:159], v[184:187], v[104:107], v[144:159]
    s_waitcnt vmcnt(4)
    s_waitcnt lgkmcnt(4)
    v_mfma_f32_32x32x16_bf16 v[160:175], v[196:199], v[108:111], v[160:175]
    ds_read_b64_tr_b16 v[184:185], v12 offset:23552
    ds_read_b64_tr_b16 v[186:187], v134 offset:24064
    ds_read_b64_tr_b16 v[188:189], v13 offset:23552
    ds_read_b64_tr_b16 v[190:191], v135 offset:24064
    v_mfma_f32_32x32x16_bf16 v[144:159], v[192:195], v[108:111], v[144:159]
    v_max3_u32 v5, v5, v104, v108
    s_waitcnt vmcnt(3)
    s_waitcnt lgkmcnt(4)
    v_mfma_f32_32x32x16_bf16 v[160:175], v[180:183], v[112:115], v[160:175]
    ds_read_b64_tr_b16 v[192:193], v12 offset:25088
    ds_read_b64_tr_b16 v[194:195], v12 offset:25600
    ds_read_b64_tr_b16 v[196:197], v13 offset:25088
    ds_read_b64_tr_b16 v[198:199], v13 offset:25600
    v_mfma_f32_32x32x16_bf16 v[144:159], v[176:179], v[112:115], v[144:159]
    s_waitcnt vmcnt(2)
    s_waitcnt lgkmcnt(4)
    v_mfma_f32_32x32x16_bf16 v[160:175], v[188:191], v[116:119], v[160:175]
    ds_read_b64_tr_b16 v[176:177], v12 offset:27136
    ds_read_b64_tr_b16 v[178:179], v134 offset:27648
    ds_read_b64_tr_b16 v[180:181], v13 offset:27136
    ds_read_b64_tr_b16 v[182:183], v135 offset:27648
    v_mfma_f32_32x32x16_bf16 v[144:159], v[184:187], v[116:119], v[144:159]
    v_max3_u32 v5, v5, v112, v116
    s_waitcnt vmcnt(1)
    s_waitcnt lgkmcnt(4)
    v_mfma_f32_32x32x16_bf16 v[160:175], v[196:199], v[120:123], v[160:175]
    v_mfma_f32_32x32x16_bf16 v[144:159], v[192:195], v[120:123], v[144:159]
    s_waitcnt vmcnt(0)
    s_waitcnt lgkmcnt(0)
    v_mfma_f32_32x32x16_bf16 v[160:175], v[180:183], v[124:127], v[160:175]
    v_mfma_f32_32x32x16_bf16 v[144:159], v[176:179], v[124:127], v[144:159]
    v_max3_u32 v5, v5, v120, v124
    v_cmp_eq_u32 vcc, -1, v5
    s_cmp_eq_u64 vcc, 0
    s_cbranch_scc1 L_p3ok
    s_nop 7
    s_sub_u32 s79, s79, 1
    s_cbranch_scc0 L_p3a
    s_mov_b32 s79, 0
L_p3ok:
    s_nop 6
    ds_write_b128 v6, v[160:163] offset:0
    ds_write_b128 v6, v[164:167] offset:1024
    ds_write_b128 v6, v[168:171] offset:2048
    ds_write_b128 v6, v[172:175] offset:3072
    s_waitcnt lgkmcnt(0)
    s_barrier
    ds_read_b128 v[64:67], v7 offset:0
    ds_read_b128 v[68:71], v7 offset:1024
    ds_read_b128 v[72:75], v7 offset:2048
    ds_read_b128 v[76:79], v7 offset:3072
    s_waitcnt lgkmcnt(3)
    v_pk_add_f32 v[144:145], v[144:145], v[64:65]
    v_pk_add_f32 v[146:147], v[146:147], v[66:67]
    v_cvt_pk_bf16_f32 v80, v144, v145
    v_cvt_pk_bf16_f32 v81, v146, v147
    s_waitcnt lgkmcnt(2)
    v_pk_add_f32 v[148:149], v[148:149], v[68:69]
    v_pk_add_f32 v[150:151], v[150:151], v[70:71]
    v_cvt_pk_bf16_f32 v82, v148, v149
    v_cvt_pk_bf16_f32 v83, v150, v151
    buffer_store_dwordx4 v[80:83], v14, s[24:27], 0 offen offset:0
    s_waitcnt lgkmcnt(1)
    v_pk_add_f32 v[152:153], v[152:153], v[72:73]
    v_pk_add_f32 v[154:155], v[154:155], v[74:75]
    v_cvt_pk_bf16_f32 v84, v152, v153
    v_cvt_pk_bf16_f32 v85, v154, v155
    s_waitcnt lgkmcnt(0)
    v_pk_add_f32 v[156:157], v[156:157], v[76:77]
    v_pk_add_f32 v[158:159], v[158:159], v[78:79]
    v_cvt_pk_bf16_f32 v86, v156, v157
    v_cvt_pk_bf16_f32 v87, v158, v159
    buffer_store_dwordx4 v[84:87], v14, s[24:27], 0 offen offset:32
    s_or_b32 s73, s2, s3
    s_cmp_lg_u32 s73, 0
    s_cbranch_scc1 L_fin
    v_mov_b32 v2, 1073741824
    v_mov_b32 v3, 16711680
    v_cndmask_b32 v2, v2, v3, s[90:91]
    buffer_store_dword v30, v2, s[20:23], 0 offen sc1
    s_branch L_fin
L_main:
    s_waitcnt lgkmcnt(0)
    s_setprio 2
    s_mov_b32 s73, 16711680
    s_load_dword s60, s[58:59], s73
    s_and_b32 s73, s2, 7
    s_lshr_b32 s74, s2, 3
    s_and_b32 s66, s74, 1
    s_lshl_b32 s75, s73, 1
    s_add_u32 s63, s75, s66
    s_lshr_b32 s64, s74, 1
    s_mul_i32 s75, s63, 7
    s_lshr_b32 s65, s75, 1
    s_mul_i32 s75, s74, 37
    s_lshr_b32 s75, s75, 8
    s_mul_i32 s76, s75, 7
    s_sub_u32 s68, s74, s76
    s_lshl_b32 s76, s73, 2
    s_add_u32 s67, s76, s75
    s_cmp_lt_u32 s74, 28
    s_cselect_b32 s69, 1, 0
    s_cselect_b32 s67, s67, 0
    s_mul_i32 s75, s63, 28
    s_lshr_b32 s70, s75, 6
    s_add_u32 s75, s75, 27
    s_lshr_b32 s71, s75, 6
    s_mov_b32 s79, 262144
    s_mov_b32 s80, 0
    s_lshl_b32 s75, s62, 4
    s_add_u32 s75, s75, s61
    s_lshl_b32 s97, s75, 7
    s_lshl_b32 s75, s63, 4
    s_add_u32 s75, s75, s64
    s_lshl_b32 s96, s75, 7
    v_cmp_eq_u32 s[90:91], 0, v1
    v_mov_b32 v27, 0
    v_mov_b32 v17, 155648
    v_mov_b32 v16, 1
    s_mov_b32 s20, s58
    s_mov_b32 s21, s59
    s_mov_b32 s22, 17825792
    s_mov_b32 s23, 0x20000
    v_lshlrev_b32 v2, 2, v1
    v_add_u32 v2, 155648, v2
    ds_write_b32 v2, v27
    s_lshl_b32 s73, s64, 2
    s_add_u32 s73, s73, s3
    s_lshl_b32 s73, s73, 16
    s_lshl_b32 s74, s63, 11
    s_add_u32 s73, s73, s74
    s_add_u32 s73, s73, 11796480
    v_add_u32 v19, s73, v0
    s_mov_b32 s0, 0
    s_mov_b32 s1, -1
    s_mov_b32 s38, 0
    s_cmp_ge_u32 s62, 14
    s_cbranch_scc1 L_m_gate
    s_cmp_ge_u32 s62, 7
    s_cbranch_scc1 L_m_N
    s_and_b32 s73, s3, 1
    s_lshr_b32 s74, s3, 1
    s_lshl_b32 s75, s73, 13
    v_and_b32 v2, 31, v1
    v_mov_b32 v3, v2
    v_lshrrev_b32 v4, 5, v1
    v_lshrrev_b32 v5, 1, v3
    v_and_b32 v5, 7, v5
    v_lshlrev_b32 v3, 7, v3
    v_add_u32 v3, s75, v3
    v_add_u32 v2, 0, v4
    v_xor_b32 v2, v2, v5
    v_lshl_add_u32 v128, v2, 4, v3
    v_add_u32 v132, 65536, v128
    v_add_u32 v2, 2, v4
    v_xor_b32 v2, v2, v5
    v_lshl_add_u32 v129, v2, 4, v3
    v_add_u32 v133, 65536, v129
    v_add_u32 v2, 4, v4
    v_xor_b32 v2, v2, v5
    v_lshl_add_u32 v130, v2, 4, v3
    v_add_u32 v134, 65536, v130
    v_add_u32 v2, 6, v4
    v_xor_b32 v2, v2, v5
    v_lshl_add_u32 v131, v2, 4, v3
    v_add_u32 v135, 65536, v131
    v_and_b32 v2, 3, v1
    v_and_b32 v3, 1, v2
    v_lshrrev_b32 v2, 1, v2
    v_lshl_or_b32 v2, v3, 1, v2
    v_bfe_u32 v3, v1, 4, 1
    v_lshl_or_b32 v2, v3, 2, v2
    v_bfe_u32 v3, v1, 2, 2
    v_lshrrev_b32 v4, 5, v1
    v_lshl_add_u32 v3, v4, 3, v3
    v_lshlrev_b32 v3, 7, v3
    v_lshl_add_u32 v3, v2, 3, v3
    v_bfe_u32 v2, v1, 3, 1
    v_lshl_or_b32 v5, v2, 6, v3
    s_lshl_b32 s75, s74, 13
    s_add_u32 s75, s75, 16384
    v_add_u32 v140, s75, v5
    v_xor_b32 v141, 64, v140
    v_add_u32 v142, 65536, v140
    v_add_u32 v143, 65536, v141
    s_lshl_b32 s75, s61, 2
    s_lshl_b32 s76, s73, 1
    s_add_u32 s75, s75, s76
    s_lshl_b32 s76, s62, 1
    s_add_u32 s76, s76, s74
    s_mul_i32 s77, s75, 86016
    s_lshl_b32 s78, s76, 12
    s_add_u32 s78, s78, s77
    v_add_u32 v146, s78, v0
    s_cmp_lt_u32 s76, 7
    s_cselect_b32 s84, 0x3e8b97f6, 1.0
    s_mov_b32 s72, 86016
    s_waitcnt lgkmcnt(0)
    s_add_u32 s60, s60, 0x9e3779b1
    v_mov_b32 v30, s60
    s_barrier
    ds_read_b128 v[32:35], v128 offset:0
    ds_read_b64_tr_b16 v[40:41], v140 offset:0
    ds_read_b64_tr_b16 v[42:43], v140 offset:512
    ds_read_b64_tr_b16 v[44:45], v141 offset:0
    ds_read_b64_tr_b16 v[46:47], v141 offset:512
    ds_read_b128 v[36:39], v128 offset:4096
    s_waitcnt lgkmcnt(0)
    v_mfma_f32_32x32x16_bf16 v[64:79], v[40:43], v[32:35], 0
    ds_read_b128 v[48:51], v129 offset:0
    ds_read_b64_tr_b16 v[56:57], v140 offset:2048
    ds_read_b64_tr_b16 v[58:59], v140 offset:2560
    v_mfma_f32_32x32x16_bf16 v[80:95], v[44:47], v[32:35], 0
    ds_read_b64_tr_b16 v[60:61], v141 offset:2048
    ds_read_b64_tr_b16 v[62:63], v141 offset:2560
    ds_read_b128 v[52:55], v129 offset:4096
    v_mfma_f32_32x32x16_bf16 v[96:111], v[40:43], v[36:39], 0
    v_mfma_f32_32x32x16_bf16 v[112:127], v[44:47], v[36:39], 0
    s_waitcnt lgkmcnt(0)
    v_mfma_f32_32x32x16_bf16 v[64:79], v[56:59], v[48:51], v[64:79]
    ds_read_b128 v[32:35], v130 offset:0
    ds_read_b64_tr_b16 v[40:41], v140 offset:4096
    ds_read_b64_tr_b16 v[42:43], v140 offset:4608
    v_mfma_f32_32x32x16_bf16 v[80:95], v[60:63], v[48:51], v[80:95]
    ds_read_b64_tr_b16 v[44:45], v141 offset:4096
    ds_read_b64_tr_b16 v[46:47], v141 offset:4608
    ds_read_b128 v[36:39], v130 offset:4096
    v_mfma_f32_32x32x16_bf16 v[96:111], v[56:59], v[52:55], v[96:111]
    v_mfma_f32_32x32x16_bf16 v[112:127], v[60:63], v[52:55], v[112:127]
    s_waitcnt lgkmcnt(0)
    v_mfma_f32_32x32x16_bf16 v[64:79], v[40:43], v[32:35], v[64:79]
    ds_read_b128 v[48:51], v131 offset:0
    ds_read_b64_tr_b16 v[56:57], v140 offset:6144
    ds_read_b64_tr_b16 v[58:59], v140 offset:6656
    v_mfma_f32_32x32x16_bf16 v[80:95], v[44:47], v[32:35], v[80:95]
    ds_read_b64_tr_b16 v[60:61], v141 offset:6144
    ds_read_b64_tr_b16 v[62:63], v141 offset:6656
    ds_read_b128 v[52:55], v131 offset:4096
    v_mfma_f32_32x32x16_bf16 v[96:111], v[40:43], v[36:39], v[96:111]
    v_mfma_f32_32x32x16_bf16 v[112:127], v[44:47], v[36:39], v[112:127]
    s_waitcnt lgkmcnt(0)
    v_mfma_f32_32x32x16_bf16 v[64:79], v[56:59], v[48:51], v[64:79]
    s_barrier
    ds_read_b128 v[32:35], v128 offset:32768
    ds_read_b64_tr_b16 v[40:41], v140 offset:32768
    ds_read_b64_tr_b16 v[42:43], v140 offset:33280
    v_mfma_f32_32x32x16_bf16 v[80:95], v[60:63], v[48:51], v[80:95]
    ds_read_b64_tr_b16 v[44:45], v141 offset:32768
    ds_read_b64_tr_b16 v[46:47], v141 offset:33280
    ds_read_b128 v[36:39], v128 offset:36864
    v_mfma_f32_32x32x16_bf16 v[96:111], v[56:59], v[52:55], v[96:111]
    v_mfma_f32_32x32x16_bf16 v[112:127], v[60:63], v[52:55], v[112:127]
    s_waitcnt lgkmcnt(0)
    v_mfma_f32_32x32x16_bf16 v[64:79], v[40:43], v[32:35], v[64:79]
    ds_read_b128 v[48:51], v129 offset:32768
    ds_read_b64_tr_b16 v[56:57], v140 offset:34816
    ds_read_b64_tr_b16 v[58:59], v140 offset:35328
    v_mfma_f32_32x32x16_bf16 v[80:95], v[44:47], v[32:35], v[80:95]
    ds_read_b64_tr_b16 v[60:61], v141 offset:34816
    ds_read_b64_tr_b16 v[62:63], v141 offset:35328
    ds_read_b128 v[52:55], v129 offset:36864
    v_mfma_f32_32x32x16_bf16 v[96:111], v[40:43], v[36:39], v[96:111]
    v_mfma_f32_32x32x16_bf16 v[112:127], v[44:47], v[36:39], v[112:127]
    s_waitcnt lgkmcnt(0)
    v_mfma_f32_32x32x16_bf16 v[64:79], v[56:59], v[48:51], v[64:79]
    ds_read_b128 v[32:35], v130 offset:32768
    ds_read_b64_tr_b16 v[40:41], v140 offset:36864
    ds_read_b64_tr_b16 v[42:43], v140 offset:37376
    v_mfma_f32_32x32x16_bf16 v[80:95], v[60:63], v[48:51], v[80:95]
    ds_read_b64_tr_b16 v[44:45], v141 offset:36864
    ds_read_b64_tr_b16 v[46:47], v141 offset:37376
    ds_read_b128 v[36:39], v130 offset:36864
    v_mfma_f32_32x32x16_bf16 v[96:111], v[56:59], v[52:55], v[96:111]
    v_mfma_f32_32x32x16_bf16 v[112:127], v[60:63], v[52:55], v[112:127]
    s_waitcnt lgkmcnt(0)
    v_mfma_f32_32x32x16_bf16 v[64:79], v[40:43], v[32:35], v[64:79]
    ds_read_b128 v[48:51], v131 offset:32768
    ds_read_b64_tr_b16 v[56:57], v140 offset:38912
    ds_read_b64_tr_b16 v[58:59], v140 offset:39424
    v_mfma_f32_32x32x16_bf16 v[80:95], v[44:47], v[32:35], v[80:95]
    ds_read_b64_tr_b16 v[60:61], v141 offset:38912
    ds_read_b64_tr_b16 v[62:63], v141 offset:39424
    ds_read_b128 v[52:55], v131 offset:36864
    v_mfma_f32_32x32x16_bf16 v[96:111], v[40:43], v[36:39], v[96:111]
    v_mfma_f32_32x32x16_bf16 v[112:127], v[44:47], v[36:39], v[112:127]
    s_waitcnt lgkmcnt(0)
    v_mfma_f32_32x32x16_bf16 v[64:79], v[56:59], v[48:51], v[64:79]
    s_barrier
    ds_read_b128 v[32:35], v132 offset:0
    ds_read_b64_tr_b16 v[40:41], v142 offset:0
    ds_read_b64_tr_b16 v[42:43], v142 offset:512
    v_mfma_f32_32x32x16_bf16 v[80:95], v[60:63], v[48:51], v[80:95]
    ds_read_b64_tr_b16 v[44:45], v143 offset:0
    ds_read_b64_tr_b16 v[46:47], v143 offset:512
    ds_read_b128 v[36:39], v132 offset:4096
    v_mfma_f32_32x32x16_bf16 v[96:111], v[56:59], v[52:55], v[96:111]
    v_mfma_f32_32x32x16_bf16 v[112:127], v[60:63], v[52:55], v[112:127]
    s_waitcnt lgkmcnt(0)
    v_mfma_f32_32x32x16_bf16 v[64:79], v[40:43], v[32:35], v[64:79]
    ds_read_b128 v[48:51], v133 offset:0
    ds_read_b64_tr_b16 v[56:57], v142 offset:2048
    ds_read_b64_tr_b16 v[58:59], v142 offset:2560
    v_mfma_f32_32x32x16_bf16 v[80:95], v[44:47], v[32:35], v[80:95]
    ds_read_b64_tr_b16 v[60:61], v143 offset:2048
    ds_read_b64_tr_b16 v[62:63], v143 offset:2560
    ds_read_b128 v[52:55], v133 offset:4096
    v_mfma_f32_32x32x16_bf16 v[96:111], v[40:43], v[36:39], v[96:111]
    v_mfma_f32_32x32x16_bf16 v[112:127], v[44:47], v[36:39], v[112:127]
    s_waitcnt lgkmcnt(0)
    v_mfma_f32_32x32x16_bf16 v[64:79], v[56:59], v[48:51], v[64:79]
    ds_read_b128 v[32:35], v134 offset:0
    ds_read_b64_tr_b16 v[40:41], v142 offset:4096
    ds_read_b64_tr_b16 v[42:43], v142 offset:4608
    v_mfma_f32_32x32x16_bf16 v[80:95], v[60:63], v[48:51], v[80:95]
    ds_read_b64_tr_b16 v[44:45], v143 offset:4096
    ds_read_b64_tr_b16 v[46:47], v143 offset:4608
    ds_read_b128 v[36:39], v134 offset:4096
    v_mfma_f32_32x32x16_bf16 v[96:111], v[56:59], v[52:55], v[96:111]
    v_mfma_f32_32x32x16_bf16 v[112:127], v[60:63], v[52:55], v[112:127]
    s_waitcnt lgkmcnt(0)
    v_mfma_f32_32x32x16_bf16 v[64:79], v[40:43], v[32:35], v[64:79]
    ds_read_b128 v[48:51], v135 offset:0
    ds_read_b64_tr_b16 v[56:57], v142 offset:6144
    ds_read_b64_tr_b16 v[58:59], v142 offset:6656
    v_mfma_f32_32x32x16_bf16 v[80:95], v[44:47], v[32:35], v[80:95]
    ds_read_b64_tr_b16 v[60:61], v143 offset:6144
    ds_read_b64_tr_b16 v[62:63], v143 offset:6656
    ds_read_b128 v[52:55], v135 offset:4096
    v_mfma_f32_32x32x16_bf16 v[96:111], v[40:43], v[36:39], v[96:111]
    v_mfma_f32_32x32x16_bf16 v[112:127], v[44:47], v[36:39], v[112:127]
    s_waitcnt lgkmcnt(0)
    v_mfma_f32_32x32x16_bf16 v[64:79], v[56:59], v[48:51], v[64:79]
    s_barrier
    ds_read_b128 v[32:35], v132 offset:32768
    ds_read_b64_tr_b16 v[40:41], v142 offset:32768
    ds_read_b64_tr_b16 v[42:43], v142 offset:33280
    v_mfma_f32_32x32x16_bf16 v[80:95], v[60:63], v[48:51], v[80:95]
    ds_read_b64_tr_b16 v[44:45], v143 offset:32768
    ds_read_b64_tr_b16 v[46:47], v143 offset:33280
    ds_read_b128 v[36:39], v132 offset:36864
    v_mfma_f32_32x32x16_bf16 v[96:111], v[56:59], v[52:55], v[96:111]
    v_mfma_f32_32x32x16_bf16 v[112:127], v[60:63], v[52:55], v[112:127]
    s_waitcnt lgkmcnt(0)
    v_mfma_f32_32x32x16_bf16 v[64:79], v[40:43], v[32:35], v[64:79]
    ds_read_b128 v[48:51], v133 offset:32768
    ds_read_b64_tr_b16 v[56:57], v142 offset:34816
    ds_read_b64_tr_b16 v[58:59], v142 offset:35328
    v_mfma_f32_32x32x16_bf16 v[80:95], v[44:47], v[32:35], v[80:95]
    ds_read_b64_tr_b16 v[60:61], v143 offset:34816
    ds_read_b64_tr_b16 v[62:63], v143 offset:35328
    ds_read_b128 v[52:55], v133 offset:36864
    v_mfma_f32_32x32x16_bf16 v[96:111], v[40:43], v[36:39], v[96:111]
    v_mfma_f32_32x32x16_bf16 v[112:127], v[44:47], v[36:39], v[112:127]
    s_waitcnt lgkmcnt(0)
    v_mfma_f32_32x32x16_bf16 v[64:79], v[56:59], v[48:51], v[64:79]
    ds_read_b128 v[32:35], v134 offset:32768
    ds_read_b64_tr_b16 v[40:41], v142 offset:36864
    ds_read_b64_tr_b16 v[42:43], v142 offset:37376
    v_mfma_f32_32x32x16_bf16 v[80:95], v[60:63], v[48:51], v[80:95]
    ds_read_b64_tr_b16 v[44:45], v143 offset:36864
    ds_read_b64_tr_b16 v[46:47], v143 offset:37376
    ds_read_b128 v[36:39], v134 offset:36864
    v_mfma_f32_32x32x16_bf16 v[96:111], v[56:59], v[52:55], v[96:111]
    v_mfma_f32_32x32x16_bf16 v[112:127], v[60:63], v[52:55], v[112:127]
    s_waitcnt lgkmcnt(0)
    v_mfma_f32_32x32x16_bf16 v[64:79], v[40:43], v[32:35], v[64:79]
    ds_read_b128 v[48:51], v135 offset:32768
    ds_read_b64_tr_b16 v[56:57], v142 offset:38912
    ds_read_b64_tr_b16 v[58:59], v142 offset:39424
    v_mfma_f32_32x32x16_bf16 v[80:95], v[44:47], v[32:35], v[80:95]
    ds_read_b64_tr_b16 v[60:61], v143 offset:38912
    ds_read_b64_tr_b16 v[62:63], v143 offset:39424
    ds_read_b128 v[52:55], v135 offset:36864
    v_mfma_f32_32x32x16_bf16 v[96:111], v[40:43], v[36:39], v[96:111]
    v_mfma_f32_32x32x16_bf16 v[112:127], v[44:47], v[36:39], v[112:127]
    s_waitcnt lgkmcnt(0)
    v_mfma_f32_32x32x16_bf16 v[64:79], v[56:59], v[48:51], v[64:79]
    s_barrier
    ds_read_b128 v[32:35], v128 offset:0
    ds_read_b64_tr_b16 v[40:41], v140 offset:0
    ds_read_b64_tr_b16 v[42:43], v140 offset:512
    v_mfma_f32_32x32x16_bf16 v[80:95], v[60:63], v[48:51], v[80:95]
    ds_read_b64_tr_b16 v[44:45], v141 offset:0
    ds_read_b64_tr_b16 v[46:47], v141 offset:512
    ds_read_b128 v[36:39], v128 offset:4096
    v_mfma_f32_32x32x16_bf16 v[96:111], v[56:59], v[52:55], v[96:111]
    v_mfma_f32_32x32x16_bf16 v[112:127], v[60:63], v[52:55], v[112:127]
    s_waitcnt lgkmcnt(0)
    v_mfma_f32_32x32x16_bf16 v[64:79], v[40:43], v[32:35], v[64:79]
    ds_read_b128 v[48:51], v129 offset:0
    ds_read_b64_tr_b16 v[56:57], v140 offset:2048
    ds_read_b64_tr_b16 v[58:59], v140 offset:2560
    v_mfma_f32_32x32x16_bf16 v[80:95], v[44:47], v[32:35], v[80:95]
    ds_read_b64_tr_b16 v[60:61], v141 offset:2048
    ds_read_b64_tr_b16 v[62:63], v141 offset:2560
    ds_read_b128 v[52:55], v129 offset:4096
    v_mfma_f32_32x32x16_bf16 v[96:111], v[40:43], v[36:39], v[96:111]
    v_mfma_f32_32x32x16_bf16 v[112:127], v[44:47], v[36:39], v[112:127]
    s_waitcnt lgkmcnt(0)
    v_mfma_f32_32x32x16_bf16 v[64:79], v[56:59], v[48:51], v[64:79]
    ds_read_b128 v[32:35], v130 offset:0
    ds_read_b64_tr_b16 v[40:41], v140 offset:4096
    ds_read_b64_tr_b16 v[42:43], v140 offset:4608
    v_mfma_f32_32x32x16_bf16 v[80:95], v[60:63], v[48:51], v[80:95]
    ds_read_b64_tr_b16 v[44:45], v141 offset:4096
    ds_read_b64_tr_b16 v[46:47], v141 offset:4608
    ds_read_b128 v[36:39], v130 offset:4096
    v_mfma_f32_32x32x16_bf16 v[96:111], v[56:59], v[52:55], v[96:111]
    v_mfma_f32_32x32x16_bf16 v[112:127], v[60:63], v[52:55], v[112:127]
    s_waitcnt lgkmcnt(0)
    v_mfma_f32_32x32x16_bf16 v[64:79], v[40:43], v[32:35], v[64:79]
    ds_read_b128 v[48:51], v131 offset:0
    ds_read_b64_tr_b16 v[56:57], v140 offset:6144
    ds_read_b64_tr_b16 v[58:59], v140 offset:6656
    v_mfma_f32_32x32x16_bf16 v[80:95], v[44:47], v[32:35], v[80:95]
    ds_read_b64_tr_b16 v[60:61], v141 offset:6144
    ds_read_b64_tr_b16 v[62:63], v141 offset:6656
    ds_read_b128 v[52:55], v131 offset:4096
    v_mfma_f32_32x32x16_bf16 v[96:111], v[40:43], v[36:39], v[96:111]
    v_mfma_f32_32x32x16_bf16 v[112:127], v[44:47], v[36:39], v[112:127]
    s_waitcnt lgkmcnt(0)
    v_mfma_f32_32x32x16_bf16 v[64:79], v[56:59], v[48:51], v[64:79]
    s_barrier
    ds_read_b128 v[32:35], v128 offset:32768
    ds_read_b64_tr_b16 v[40:41], v140 offset:32768
    ds_read_b64_tr_b16 v[42:43], v140 offset:33280
    v_mfma_f32_32x32x16_bf16 v[80:95], v[60:63], v[48:51], v[80:95]
    ds_read_b64_tr_b16 v[44:45], v141 offset:32768
    ds_read_b64_tr_b16 v[46:47], v141 offset:33280
    ds_read_b128 v[36:39], v128 offset:36864
    v_mfma_f32_32x32x16_bf16 v[96:111], v[56:59], v[52:55], v[96:111]
    v_mfma_f32_32x32x16_bf16 v[112:127], v[60:63], v[52:55], v[112:127]
    s_waitcnt lgkmcnt(0)
    v_mfma_f32_32x32x16_bf16 v[64:79], v[40:43], v[32:35], v[64:79]
    ds_read_b128 v[48:51], v129 offset:32768
    ds_read_b64_tr_b16 v[56:57], v140 offset:34816
    ds_read_b64_tr_b16 v[58:59], v140 offset:35328
    v_mfma_f32_32x32x16_bf16 v[80:95], v[44:47], v[32:35], v[80:95]
    ds_read_b64_tr_b16 v[60:61], v141 offset:34816
    ds_read_b64_tr_b16 v[62:63], v141 offset:35328
    ds_read_b128 v[52:55], v129 offset:36864
    v_mfma_f32_32x32x16_bf16 v[96:111], v[40:43], v[36:39], v[96:111]
    v_mfma_f32_32x32x16_bf16 v[112:127], v[44:47], v[36:39], v[112:127]
    s_waitcnt lgkmcnt(0)
    v_mfma_f32_32x32x16_bf16 v[64:79], v[56:59], v[48:51], v[64:79]
    ds_read_b128 v[32:35], v130 offset:32768
    ds_read_b64_tr_b16 v[40:41], v140 offset:36864
    ds_read_b64_tr_b16 v[42:43], v140 offset:37376
    v_mfma_f32_32x32x16_bf16 v[80:95], v[60:63], v[48:51], v[80:95]
    ds_read_b64_tr_b16 v[44:45], v141 offset:36864
    ds_read_b64_tr_b16 v[46:47], v141 offset:37376
    ds_read_b128 v[36:39], v130 offset:36864
    v_mfma_f32_32x32x16_bf16 v[96:111], v[56:59], v[52:55], v[96:111]
    v_mfma_f32_32x32x16_bf16 v[112:127], v[60:63], v[52:55], v[112:127]
    s_waitcnt lgkmcnt(0)
    v_mfma_f32_32x32x16_bf16 v[64:79], v[40:43], v[32:35], v[64:79]
    ds_read_b128 v[48:51], v131 offset:32768
    ds_read_b64_tr_b16 v[56:57], v140 offset:38912
    ds_read_b64_tr_b16 v[58:59], v140 offset:39424
    v_mfma_f32_32x32x16_bf16 v[80:95], v[44:47], v[32:35], v[80:95]
    ds_read_b64_tr_b16 v[60:61], v141 offset:38912
    ds_read_b64_tr_b16 v[62:63], v141 offset:39424
    ds_read_b128 v[52:55], v131 offset:36864
    v_mfma_f32_32x32x16_bf16 v[96:111], v[40:43], v[36:39], v[96:111]
    v_mfma_f32_32x32x16_bf16 v[112:127], v[44:47], v[36:39], v[112:127]
    s_waitcnt lgkmcnt(0)
    v_mfma_f32_32x32x16_bf16 v[64:79], v[56:59], v[48:51], v[64:79]
    s_barrier
    ds_read_b128 v[192:195], v132 offset:0
    ds_read_b64_tr_b16 v[200:201], v142 offset:0
    ds_read_b64_tr_b16 v[202:203], v142 offset:512
    v_mfma_f32_32x32x16_bf16 v[80:95], v[60:63], v[48:51], v[80:95]
    ds_read_b128 v[208:211], v133 offset:0
    ds_read_b64_tr_b16 v[216:217], v142 offset:2048
    ds_read_b64_tr_b16 v[218:219], v142 offset:2560
    v_mfma_f32_32x32x16_bf16 v[96:111], v[56:59], v[52:55], v[96:111]
    ds_read_b128 v[224:227], v134 offset:0
    ds_read_b64_tr_b16 v[232:233], v142 offset:4096
    ds_read_b64_tr_b16 v[234:235], v142 offset:4608
    v_mfma_f32_32x32x16_bf16 v[112:127], v[60:63], v[52:55], v[112:127]
    s_waitcnt lgkmcnt(8)
    s_waitcnt lgkmcnt(6)
    v_mfma_f32_32x32x16_bf16 v[64:79], v[200:203], v[192:195], v[64:79]
    ds_read_b128 v[240:243], v135 offset:0
    ds_read_b64_tr_b16 v[248:249], v142 offset:6144
    ds_read_b64_tr_b16 v[250:251], v142 offset:6656
    ds_read_b64_tr_b16 v[204:205], v143 offset:0
    s_waitcnt lgkmcnt(9)
    s_waitcnt lgkmcnt(7)
    v_mfma_f32_32x32x16_bf16 v[64:79], v[216:219], v[208:211], v[64:79]
    ds_read_b64_tr_b16 v[206:207], v143 offset:512
    ds_read_b64_tr_b16 v[220:221], v143 offset:2048
    ds_read_b64_tr_b16 v[222:223], v143 offset:2560
    ds_read_b64_tr_b16 v[236:237], v143 offset:4096
    s_waitcnt lgkmcnt(10)
    s_waitcnt lgkmcnt(8)
    v_mfma_f32_32x32x16_bf16 v[64:79], v[232:235], v[224:227], v[64:79]
    ds_read_b64_tr_b16 v[238:239], v143 offset:4608
    ds_read_b64_tr_b16 v[252:253], v143 offset:6144
    ds_read_b64_tr_b16 v[254:255], v143 offset:6656
    ds_read_b128 v[196:199], v132 offset:4096
    s_waitcnt lgkmcnt(11)
    s_waitcnt lgkmcnt(9)
    v_mfma_f32_32x32x16_bf16 v[64:79], v[248:251], v[240:243], v[64:79]
    ds_read_b128 v[212:215], v133 offset:4096
    ds_read_b128 v[228:231], v134 offset:4096
    ds_read_b128 v[244:247], v135 offset:4096
    s_waitcnt lgkmcnt(10)
    v_mfma_f32_32x32x16_bf16 v[80:95], v[204:207], v[192:195], v[80:95]
    s_waitcnt lgkmcnt(8)
    v_mfma_f32_32x32x16_bf16 v[80:95], v[220:223], v[208:211], v[80:95]
    s_waitcnt lgkmcnt(6)
    v_mfma_f32_32x32x16_bf16 v[80:95], v[236:239], v[224:227], v[80:95]
    s_waitcnt lgkmcnt(4)
    v_mfma_f32_32x32x16_bf16 v[80:95], v[252:255], v[240:243], v[80:95]
    s_nop 0
    v_mul_f32 v64, s84, v64
    v_mul_f32 v65, s84, v65
    v_cvt_pk_bf16_f32 v160, v64, v65
    v_mul_f32 v66, s84, v66
    v_mul_f32 v67, s84, v67
    v_cvt_pk_bf16_f32 v161, v66, v67
    s_waitcnt lgkmcnt(3)
    v_mfma_f32_32x32x16_bf16 v[112:127], v[204:207], v[196:199], v[112:127]
    v_mul_f32 v68, s84, v68
    v_mul_f32 v69, s84, v69
    v_cvt_pk_bf16_f32 v162, v68, v69
    v_mul_f32 v70, s84, v70
    v_mul_f32 v71, s84, v71
    v_cvt_pk_bf16_f32 v163, v70, v71
    s_waitcnt lgkmcnt(2)
    v_mfma_f32_32x32x16_bf16 v[112:127], v[220:223], v[212:215], v[112:127]
    buffer_store_dwordx4 v[160:163], v146, s[20:23], 0 offen offset:0 sc1
    v_mul_f32 v72, s84, v72
    v_mul_f32 v73, s84, v73
    v_cvt_pk_bf16_f32 v164, v72, v73
    v_mul_f32 v74, s84, v74
    v_mul_f32 v75, s84, v75
    s_waitcnt lgkmcnt(1)
    v_mfma_f32_32x32x16_bf16 v[112:127], v[236:239], v[228:231], v[112:127]
    v_cvt_pk_bf16_f32 v165, v74, v75
    v_mul_f32 v76, s84, v76
    v_mul_f32 v77, s84, v77
    v_cvt_pk_bf16_f32 v166, v76, v77
    v_mul_f32 v78, s84, v78
    v_mul_f32 v79, s84, v79
    s_waitcnt lgkmcnt(0)
    v_mfma_f32_32x32x16_bf16 v[112:127], v[252:255], v[244:247], v[112:127]
    s_mov_b64 exec, 1
    ds_add_u32 v17, v16 offset:8
    s_mov_b64 exec, -1
    v_cvt_pk_bf16_f32 v167, v78, v79
    buffer_store_dwordx4 v[164:167], v146, s[20:23], 0 offen offset:1024 sc1
    v_mul_f32 v80, s84, v80
    v_mul_f32 v81, s84, v81
    v_cvt_pk_bf16_f32 v168, v80, v81
    v_mul_f32 v82, s84, v82
    v_mfma_f32_32x32x16_bf16 v[96:111], v[200:203], v[196:199], v[96:111]
    v_mul_f32 v83, s84, v83
    v_cvt_pk_bf16_f32 v169, v82, v83
    v_mul_f32 v84, s84, v84
    v_mul_f32 v85, s84, v85
    v_cvt_pk_bf16_f32 v170, v84, v85
    v_mul_f32 v86, s84, v86
    v_mfma_f32_32x32x16_bf16 v[96:111], v[216:219], v[212:215], v[96:111]
    v_mul_f32 v87, s84, v87
    v_cvt_pk_bf16_f32 v171, v86, v87
    buffer_store_dwordx4 v[168:171], v146, s[20:23], 0 offen offset:2048 sc1
    v_mul_f32 v88, s84, v88
    v_mul_f32 v89, s84, v89
    v_cvt_pk_bf16_f32 v172, v88, v89
    v_mfma_f32_32x32x16_bf16 v[96:111], v[232:235], v[228:231], v[96:111]
    v_mul_f32 v90, s84, v90
    v_mul_f32 v91, s84, v91
    v_cvt_pk_bf16_f32 v173, v90, v91
    v_mul_f32 v92, s84, v92
    v_mul_f32 v93, s84, v93
    v_cvt_pk_bf16_f32 v174, v92, v93
    v_mfma_f32_32x32x16_bf16 v[96:111], v[248:251], v[244:247], v[96:111]
    v_mul_f32 v94, s84, v94
    v_mul_f32 v95, s84, v95
    v_cvt_pk_bf16_f32 v175, v94, v95
    buffer_store_dwordx4 v[172:175], v146, s[20:23], 0 offen offset:3072 sc1
    v_mul_f32 v112, s84, v112
    v_mul_f32 v113, s84, v113
    v_cvt_pk_bf16_f32 v184, v112, v113
    v_mul_f32 v114, s84, v114
    v_mul_f32 v115, s84, v115
    v_cvt_pk_bf16_f32 v185, v114, v115
    v_mul_f32 v116, s84, v116
    v_mul_f32 v117, s84, v117
    v_cvt_pk_bf16_f32 v186, v116, v117
    v_mul_f32 v118, s84, v118
    v_mul_f32 v119, s84, v119
    v_cvt_pk_bf16_f32 v187, v118, v119
    buffer_store_dwordx4 v[184:187], v146, s[20:23], s72 offen offset:2048 sc1
    v_mul_f32 v120, s84, v120
    v_mul_f32 v121, s84, v121
    v_cvt_pk_bf16_f32 v188, v120, v121
    v_mul_f32 v122, s84, v122
    v_mul_f32 v123, s84, v123
    v_cvt_pk_bf16_f32 v189, v122, v123
    v_mul_f32 v124, s84, v124
    v_mul_f32 v125, s84, v125
    v_cvt_pk_bf16_f32 v190, v124, v125
    v_mul_f32 v126, s84, v126
    v_mul_f32 v127, s84, v127
    v_cvt_pk_bf16_f32 v191, v126, v127
    buffer_store_dwordx4 v[188:191], v146, s[20:23], s72 offen offset:3072 sc1
    v_mul_f32 v96, s84, v96
    v_mul_f32 v97, s84, v97
    v_cvt_pk_bf16_f32 v176, v96, v97
    v_mul_f32 v98, s84, v98
    v_mul_f32 v99, s84, v99
    v_cvt_pk_bf16_f32 v177, v98, v99
    v_mul_f32 v100, s84, v100
    v_mul_f32 v101, s84, v101
    v_cvt_pk_bf16_f32 v178, v100, v101
    v_mul_f32 v102, s84, v102
    v_mul_f32 v103, s84, v103
    v_cvt_pk_bf16_f32 v179, v102, v103
    buffer_store_dwordx4 v[176:179], v146, s[20:23], s72 offen offset:0 sc1
    v_mul_f32 v104, s84, v104
    v_mul_f32 v105, s84, v105
    v_cvt_pk_bf16_f32 v180, v104, v105
    v_mul_f32 v106, s84, v106
    v_mul_f32 v107, s84, v107
    v_cvt_pk_bf16_f32 v181, v106, v107
    v_mul_f32 v108, s84, v108
    v_mul_f32 v109, s84, v109
    v_cvt_pk_bf16_f32 v182, v108, v109
    v_mul_f32 v110, s84, v110
    v_mul_f32 v111, s84, v111
    v_cvt_pk_bf16_f32 v183, v110, v111
    buffer_store_dwordx4 v[180:183], v146, s[20:23], s72 offen offset:1024 sc1
    s_branch L_m_join
L_m_N:
    s_and_b32 s73, s3, 1
    s_lshr_b32 s74, s3, 1
    s_lshl_b32 s75, s73, 13
    v_and_b32 v2, 31, v1
    v_and_b32 v3, 0x13, v2
    v_and_b32 v4, 4, v2
    v_lshl_or_b32 v3, v4, 1, v3
    v_lshrrev_b32 v4, 1, v2
    v_and_or_b32 v3, v4, 4, v3
    v_lshrrev_b32 v4, 5, v1
    v_lshrrev_b32 v5, 1, v3
    v_and_b32 v5, 7, v5
    v_lshlrev_b32 v3, 7, v3
    v_add_u32 v3, s75, v3
    v_add_u32 v2, 0, v4
    v_xor_b32 v2, v2, v5
    v_lshl_add_u32 v128, v2, 4, v3
    v_add_u32 v132, 65536, v128
    v_add_u32 v2, 2, v4
    v_xor_b32 v2, v2, v5
    v_lshl_add_u32 v129, v2, 4, v3
    v_add_u32 v133, 65536, v129
    v_add_u32 v2, 4, v4
    v_xor_b32 v2, v2, v5
    v_lshl_add_u32 v130, v2, 4, v3
    v_add_u32 v134, 65536, v130
    v_add_u32 v2, 6, v4
    v_xor_b32 v2, v2, v5
    v_lshl_add_u32 v131, v2, 4, v3
    v_add_u32 v135, 65536, v131
    v_and_b32 v2, 3, v1
    v_bfe_u32 v3, v1, 4, 1
    v_lshl_or_b32 v2, v3, 2, v2
    v_bfe_u32 v3, v1, 2, 2
    v_lshrrev_b32 v4, 5, v1
    v_lshl_add_u32 v3, v4, 3, v3
    v_lshlrev_b32 v3, 7, v3
    v_lshl_add_u32 v3, v2, 3, v3
    v_bfe_u32 v2, v1, 3, 1
    v_lshl_or_b32 v5, v2, 6, v3
    s_lshl_b32 s75, s74, 13
    s_add_u32 s75, s75, 16384
    v_add_u32 v140, s75, v5
    v_xor_b32 v141, 64, v140
    v_add_u32 v142, 65536, v140
    v_add_u32 v143, 65536, v141
    s_lshl_b32 s75, s61, 2
    s_lshl_b32 s76, s73, 1
    s_add_u32 s75, s75, s76
    s_lshl_b32 s76, s62, 1
    s_add_u32 s76, s76, s74
    s_lshl_b32 s75, s75, 11
    s_add_u32 s75, s75, 5505024
    s_sub_u32 s76, s76, 14
    s_sub_u32 s77, s76, 7
    s_cmp_lt_u32 s76, 7
    s_cselect_b32 s76, s76, s77
    s_cselect_b32 s77, 0, 2097152
    s_add_u32 s77, s77, s75
    s_lshl_b32 s73, s76, 6
    s_add_u32 s73, s73, 0
    v_and_b32 v6, 31, v1
    v_add_u32 v6, s73, v6
    s_mov_b32 s78, 2341
    v_mul_lo_u32 v2, s78, v6
    v_lshrrev_b32 v2, 16, v2
    v_mul_u32_u24 v3, 28, v2
    v_sub_u32 v3, v6, v3
    v_and_b32 v5, 0x13, v3
    v_and_b32 v4, 4, v3
    v_lshl_or_b32 v5, v4, 1, v5
    v_lshrrev_b32 v4, 1, v3
    v_and_or_b32 v5, v4, 4, v5
    v_lshlrev_b32 v2, 17, v2
    v_lshl_add_u32 v2, v5, 4, v2
    v_lshrrev_b32 v3, 5, v1
    v_lshl_add_u32 v2, v3, 9, v2
    v_add_u32 v146, s77, v2
    s_lshl_b32 s73, s76, 6
    s_add_u32 s73, s73, 32
    v_and_b32 v6, 31, v1
    v_add_u32 v6, s73, v6
    s_mov_b32 s78, 2341
    v_mul_lo_u32 v2, s78, v6
    v_lshrrev_b32 v2, 16, v2
    v_mul_u32_u24 v3, 28, v2
    v_sub_u32 v3, v6, v3
    v_and_b32 v5, 0x13, v3
    v_and_b32 v4, 4, v3
    v_lshl_or_b32 v5, v4, 1, v5
    v_lshrrev_b32 v4, 1, v3
    v_and_or_b32 v5, v4, 4, v5
    v_lshlrev_b32 v2, 17, v2
    v_lshl_add_u32 v2, v5, 4, v2
    v_lshrrev_b32 v3, 5, v1
    v_lshl_add_u32 v2, v3, 9, v2
    v_add_u32 v147, s77, v2
    s_lshl_b32 s73, s76, 6
    s_add_u32 s74, s73, 27
    s_mul_i32 s74, s74, 2341
    s_lshr_b32 s74, s74, 16
    s_add_u32 s73, s73, 64
    v_lshrrev_b32 v2, 4, v1
    v_add_u32 v2, s74, v2
    v_mul_u32_u24 v3, 28, v2
    v_cmp_gt_u32 vcc, s73, v3
    v_lshlrev_b32 v2, 17, v2
    v_bfe_u32 v3, v1, 2, 2
    v_lshl_add_u32 v2, v3, 9, v2
    v_and_b32 v3, 3, v1
    v_lshl_add_u32 v2, v3, 4, v2
    v_add_u32 v2, s77, v2
    v_add_u32 v2, 448, v2
    v_mov_b32 v4, 1073741824
    v_cndmask_b32 v148, v4, v2, vcc
    v_cmp_eq_u32 vcc, 0, v3
    v_mov_b32 v4, 0x3f803f80
    s_nop 0
    v_cndmask_b32 v152, v27, v4, vcc
    v_mov_b32 v153, v152
    v_mov_b32 v154, v152
    v_mov_b32 v155, v152
    s_waitcnt lgkmcnt(0)
    s_add_u32 s60, s60, 0x9e3779b1
    v_mov_b32 v30, s60
    s_barrier
    ds_read_b128 v[32:35], v128 offset:0
    ds_read_b64_tr_b16 v[40:41], v140 offset:0
    ds_read_b64_tr_b16 v[42:43], v140 offset:512
    ds_read_b64_tr_b16 v[44:45], v141 offset:0
    ds_read_b64_tr_b16 v[46:47], v141 offset:512
    ds_read_b128 v[36:39], v128 offset:4096
    s_waitcnt lgkmcnt(0)
    v_mfma_f32_32x32x16_bf16 v[64:79], v[32:35], v[40:43], 0
    ds_read_b128 v[48:51], v129 offset:0
    ds_read_b64_tr_b16 v[56:57], v140 offset:2048
    ds_read_b64_tr_b16 v[58:59], v140 offset:2560
    v_mfma_f32_32x32x16_bf16 v[80:95], v[32:35], v[44:47], 0
    ds_read_b64_tr_b16 v[60:61], v141 offset:2048
    ds_read_b64_tr_b16 v[62:63], v141 offset:2560
    ds_read_b128 v[52:55], v129 offset:4096
    v_mfma_f32_32x32x16_bf16 v[96:111], v[36:39], v[40:43], 0
    v_mfma_f32_32x32x16_bf16 v[112:127], v[36:39], v[44:47], 0
    s_waitcnt lgkmcnt(0)
    v_mfma_f32_32x32x16_bf16 v[64:79], v[48:51], v[56:59], v[64:79]
    ds_read_b128 v[32:35], v130 offset:0
    ds_read_b64_tr_b16 v[40:41], v140 offset:4096
    ds_read_b64_tr_b16 v[42:43], v140 offset:4608
    v_mfma_f32_32x32x16_bf16 v[80:95], v[48:51], v[60:63], v[80:95]
    ds_read_b64_tr_b16 v[44:45], v141 offset:4096
    ds_read_b64_tr_b16 v[46:47], v141 offset:4608
    ds_read_b128 v[36:39], v130 offset:4096
    v_mfma_f32_32x32x16_bf16 v[96:111], v[52:55], v[56:59], v[96:111]
    v_mfma_f32_32x32x16_bf16 v[112:127], v[52:55], v[60:63], v[112:127]
    s_waitcnt lgkmcnt(0)
    v_mfma_f32_32x32x16_bf16 v[64:79], v[32:35], v[40:43], v[64:79]
    ds_read_b128 v[48:51], v131 offset:0
    ds_read_b64_tr_b16 v[56:57], v140 offset:6144
    ds_read_b64_tr_b16 v[58:59], v140 offset:6656
    v_mfma_f32_32x32x16_bf16 v[80:95], v[32:35], v[44:47], v[80:95]
    ds_read_b64_tr_b16 v[60:61], v141 offset:6144
    ds_read_b64_tr_b16 v[62:63], v141 offset:6656
    ds_read_b128 v[52:55], v131 offset:4096
    v_mfma_f32_32x32x16_bf16 v[96:111], v[36:39], v[40:43], v[96:111]
    v_mfma_f32_32x32x16_bf16 v[112:127], v[36:39], v[44:47], v[112:127]
    s_waitcnt lgkmcnt(0)
    v_mfma_f32_32x32x16_bf16 v[64:79], v[48:51], v[56:59], v[64:79]
    s_barrier
    ds_read_b128 v[32:35], v128 offset:32768
    ds_read_b64_tr_b16 v[40:41], v140 offset:32768
    ds_read_b64_tr_b16 v[42:43], v140 offset:33280
    v_mfma_f32_32x32x16_bf16 v[80:95], v[48:51], v[60:63], v[80:95]
    ds_read_b64_tr_b16 v[44:45], v141 offset:32768
    ds_read_b64_tr_b16 v[46:47], v141 offset:33280
    ds_read_b128 v[36:39], v128 offset:36864
    v_mfma_f32_32x32x16_bf16 v[96:111], v[52:55], v[56:59], v[96:111]
    v_mfma_f32_32x32x16_bf16 v[112:127], v[52:55], v[60:63], v[112:127]
    s_waitcnt lgkmcnt(0)
    v_mfma_f32_32x32x16_bf16 v[64:79], v[32:35], v[40:43], v[64:79]
    ds_read_b128 v[48:51], v129 offset:32768
    ds_read_b64_tr_b16 v[56:57], v140 offset:34816
    ds_read_b64_tr_b16 v[58:59], v140 offset:35328
    v_mfma_f32_32x32x16_bf16 v[80:95], v[32:35], v[44:47], v[80:95]
    ds_read_b64_tr_b16 v[60:61], v141 offset:34816
    ds_read_b64_tr_b16 v[62:63], v141 offset:35328
    ds_read_b128 v[52:55], v129 offset:36864
    v_mfma_f32_32x32x16_bf16 v[96:111], v[36:39], v[40:43], v[96:111]
    v_mfma_f32_32x32x16_bf16 v[112:127], v[36:39], v[44:47], v[112:127]
    s_waitcnt lgkmcnt(0)
    v_mfma_f32_32x32x16_bf16 v[64:79], v[48:51], v[56:59], v[64:79]
    ds_read_b128 v[32:35], v130 offset:32768
    ds_read_b64_tr_b16 v[40:41], v140 offset:36864
    ds_read_b64_tr_b16 v[42:43], v140 offset:37376
    v_mfma_f32_32x32x16_bf16 v[80:95], v[48:51], v[60:63], v[80:95]
    ds_read_b64_tr_b16 v[44:45], v141 offset:36864
    ds_read_b64_tr_b16 v[46:47], v141 offset:37376
    ds_read_b128 v[36:39], v130 offset:36864
    v_mfma_f32_32x32x16_bf16 v[96:111], v[52:55], v[56:59], v[96:111]
    v_mfma_f32_32x32x16_bf16 v[112:127], v[52:55], v[60:63], v[112:127]
    s_waitcnt lgkmcnt(0)
    v_mfma_f32_32x32x16_bf16 v[64:79], v[32:35], v[40:43], v[64:79]
    ds_read_b128 v[48:51], v131 offset:32768
    ds_read_b64_tr_b16 v[56:57], v140 offset:38912
    ds_read_b64_tr_b16 v[58:59], v140 offset:39424
    v_mfma_f32_32x32x16_bf16 v[80:95], v[32:35], v[44:47], v[80:95]
    ds_read_b64_tr_b16 v[60:61], v141 offset:38912
    ds_read_b64_tr_b16 v[62:63], v141 offset:39424
    ds_read_b128 v[52:55], v131 offset:36864
    v_mfma_f32_32x32x16_bf16 v[96:111], v[36:39], v[40:43], v[96:111]
    v_mfma_f32_32x32x16_bf16 v[112:127], v[36:39], v[44:47], v[112:127]
    s_waitcnt lgkmcnt(0)
    v_mfma_f32_32x32x16_bf16 v[64:79], v[48:51], v[56:59], v[64:79]
    s_barrier
    ds_read_b128 v[32:35], v132 offset:0
    ds_read_b64_tr_b16 v[40:41], v142 offset:0
    ds_read_b64_tr_b16 v[42:43], v142 offset:512
    v_mfma_f32_32x32x16_bf16 v[80:95], v[48:51], v[60:63], v[80:95]
    ds_read_b64_tr_b16 v[44:45], v143 offset:0
    ds_read_b64_tr_b16 v[46:47], v143 offset:512
    ds_read_b128 v[36:39], v132 offset:4096
    v_mfma_f32_32x32x16_bf16 v[96:111], v[52:55], v[56:59], v[96:111]
    v_mfma_f32_32x32x16_bf16 v[112:127], v[52:55], v[60:63], v[112:127]
    s_waitcnt lgkmcnt(0)
    v_mfma_f32_32x32x16_bf16 v[64:79], v[32:35], v[40:43], v[64:79]
    ds_read_b128 v[48:51], v133 offset:0
    ds_read_b64_tr_b16 v[56:57], v142 offset:2048
    ds_read_b64_tr_b16 v[58:59], v142 offset:2560
    v_mfma_f32_32x32x16_bf16 v[80:95], v[32:35], v[44:47], v[80:95]
    ds_read_b64_tr_b16 v[60:61], v143 offset:2048
    ds_read_b64_tr_b16 v[62:63], v143 offset:2560
    ds_read_b128 v[52:55], v133 offset:4096
    v_mfma_f32_32x32x16_bf16 v[96:111], v[36:39], v[40:43], v[96:111]
    v_mfma_f32_32x32x16_bf16 v[112:127], v[36:39], v[44:47], v[112:127]
    s_waitcnt lgkmcnt(0)
    v_mfma_f32_32x32x16_bf16 v[64:79], v[48:51], v[56:59], v[64:79]
    ds_read_b128 v[32:35], v134 offset:0
    ds_read_b64_tr_b16 v[40:41], v142 offset:4096
    ds_read_b64_tr_b16 v[42:43], v142 offset:4608
    v_mfma_f32_32x32x16_bf16 v[80:95], v[48:51], v[60:63], v[80:95]
    ds_read_b64_tr_b16 v[44:45], v143 offset:4096
    ds_read_b64_tr_b16 v[46:47], v143 offset:4608
    ds_read_b128 v[36:39], v134 offset:4096
    v_mfma_f32_32x32x16_bf16 v[96:111], v[52:55], v[56:59], v[96:111]
    v_mfma_f32_32x32x16_bf16 v[112:127], v[52:55], v[60:63], v[112:127]
    s_waitcnt lgkmcnt(0)
    v_mfma_f32_32x32x16_bf16 v[64:79], v[32:35], v[40:43], v[64:79]
    ds_read_b128 v[48:51], v135 offset:0
    ds_read_b64_tr_b16 v[56:57], v142 offset:6144
    ds_read_b64_tr_b16 v[58:59], v142 offset:6656
    v_mfma_f32_32x32x16_bf16 v[80:95], v[32:35], v[44:47], v[80:95]
    ds_read_b64_tr_b16 v[60:61], v143 offset:6144
    ds_read_b64_tr_b16 v[62:63], v143 offset:6656
    ds_read_b128 v[52:55], v135 offset:4096
    v_mfma_f32_32x32x16_bf16 v[96:111], v[36:39], v[40:43], v[96:111]
    v_mfma_f32_32x32x16_bf16 v[112:127], v[36:39], v[44:47], v[112:127]
    s_waitcnt lgkmcnt(0)
    v_mfma_f32_32x32x16_bf16 v[64:79], v[48:51], v[56:59], v[64:79]
    s_barrier
    ds_read_b128 v[32:35], v132 offset:32768
    ds_read_b64_tr_b16 v[40:41], v142 offset:32768
    ds_read_b64_tr_b16 v[42:43], v142 offset:33280
    v_mfma_f32_32x32x16_bf16 v[80:95], v[48:51], v[60:63], v[80:95]
    ds_read_b64_tr_b16 v[44:45], v143 offset:32768
    ds_read_b64_tr_b16 v[46:47], v143 offset:33280
    ds_read_b128 v[36:39], v132 offset:36864
    v_mfma_f32_32x32x16_bf16 v[96:111], v[52:55], v[56:59], v[96:111]
    v_mfma_f32_32x32x16_bf16 v[112:127], v[52:55], v[60:63], v[112:127]
    s_waitcnt lgkmcnt(0)
    v_mfma_f32_32x32x16_bf16 v[64:79], v[32:35], v[40:43], v[64:79]
    buffer_store_dwordx4 v[152:155], v148, s[20:23], 0 offen offset:0 sc1
    buffer_store_dwordx4 v[152:155], v148, s[20:23], 0 offen offset:2048 sc1
    ds_read_b128 v[48:51], v133 offset:32768
    ds_read_b64_tr_b16 v[56:57], v142 offset:34816
    ds_read_b64_tr_b16 v[58:59], v142 offset:35328
    v_mfma_f32_32x32x16_bf16 v[80:95], v[32:35], v[44:47], v[80:95]
    ds_read_b64_tr_b16 v[60:61], v143 offset:34816
    ds_read_b64_tr_b16 v[62:63], v143 offset:35328
    ds_read_b128 v[52:55], v133 offset:36864
    v_mfma_f32_32x32x16_bf16 v[96:111], v[36:39], v[40:43], v[96:111]
    v_mfma_f32_32x32x16_bf16 v[112:127], v[36:39], v[44:47], v[112:127]
    s_waitcnt lgkmcnt(0)
    v_mfma_f32_32x32x16_bf16 v[64:79], v[48:51], v[56:59], v[64:79]
    ds_read_b128 v[32:35], v134 offset:32768
    ds_read_b64_tr_b16 v[40:41], v142 offset:36864
    ds_read_b64_tr_b16 v[42:43], v142 offset:37376
    v_mfma_f32_32x32x16_bf16 v[80:95], v[48:51], v[60:63], v[80:95]
    ds_read_b64_tr_b16 v[44:45], v143 offset:36864
    ds_read_b64_tr_b16 v[46:47], v143 offset:37376
    ds_read_b128 v[36:39], v134 offset:36864
    v_mfma_f32_32x32x16_bf16 v[96:111], v[52:55], v[56:59], v[96:111]
    v_mfma_f32_32x32x16_bf16 v[112:127], v[52:55], v[60:63], v[112:127]
    s_waitcnt lgkmcnt(0)
    v_mfma_f32_32x32x16_bf16 v[64:79], v[32:35], v[40:43], v[64:79]
    ds_read_b128 v[48:51], v135 offset:32768
    ds_read_b64_tr_b16 v[56:57], v142 offset:38912
    ds_read_b64_tr_b16 v[58:59], v142 offset:39424
    v_mfma_f32_32x32x16_bf16 v[80:95], v[32:35], v[44:47], v[80:95]
    ds_read_b64_tr_b16 v[60:61], v143 offset:38912
    ds_read_b64_tr_b16 v[62:63], v143 offset:39424
    ds_read_b128 v[52:55], v135 offset:36864
    v_mfma_f32_32x32x16_bf16 v[96:111], v[36:39], v[40:43], v[96:111]
    v_mfma_f32_32x32x16_bf16 v[112:127], v[36:39], v[44:47], v[112:127]
    s_waitcnt lgkmcnt(0)
    v_mfma_f32_32x32x16_bf16 v[64:79], v[48:51], v[56:59], v[64:79]
    s_barrier
    ds_read_b128 v[32:35], v128 offset:0
    ds_read_b64_tr_b16 v[40:41], v140 offset:0
    ds_read_b64_tr_b16 v[42:43], v140 offset:512
    v_mfma_f32_32x32x16_bf16 v[80:95], v[48:51], v[60:63], v[80:95]
    ds_read_b64_tr_b16 v[44:45], v141 offset:0
    ds_read_b64_tr_b16 v[46:47], v141 offset:512
    ds_read_b128 v[36:39], v128 offset:4096
    v_mfma_f32_32x32x16_bf16 v[96:111], v[52:55], v[56:59], v[96:111]
    v_mfma_f32_32x32x16_bf16 v[112:127], v[52:55], v[60:63], v[112:127]
    s_waitcnt lgkmcnt(0)
    v_mfma_f32_32x32x16_bf16 v[64:79], v[32:35], v[40:43], v[64:79]
    ds_read_b128 v[48:51], v129 offset:0
    ds_read_b64_tr_b16 v[56:57], v140 offset:2048
    ds_read_b64_tr_b16 v[58:59], v140 offset:2560
    v_mfma_f32_32x32x16_bf16 v[80:95], v[32:35], v[44:47], v[80:95]
    ds_read_b64_tr_b16 v[60:61], v141 offset:2048
    ds_read_b64_tr_b16 v[62:63], v141 offset:2560
    ds_read_b128 v[52:55], v129 offset:4096
    v_mfma_f32_32x32x16_bf16 v[96:111], v[36:39], v[40:43], v[96:111]
    v_mfma_f32_32x32x16_bf16 v[112:127], v[36:39], v[44:47], v[112:127]
    s_waitcnt lgkmcnt(0)
    v_mfma_f32_32x32x16_bf16 v[64:79], v[48:51], v[56:59], v[64:79]
    ds_read_b128 v[32:35], v130 offset:0
    ds_read_b64_tr_b16 v[40:41], v140 offset:4096
    ds_read_b64_tr_b16 v[42:43], v140 offset:4608
    v_mfma_f32_32x32x16_bf16 v[80:95], v[48:51], v[60:63], v[80:95]
    ds_read_b64_tr_b16 v[44:45], v141 offset:4096
    ds_read_b64_tr_b16 v[46:47], v141 offset:4608
    ds_read_b128 v[36:39], v130 offset:4096
    v_mfma_f32_32x32x16_bf16 v[96:111], v[52:55], v[56:59], v[96:111]
    v_mfma_f32_32x32x16_bf16 v[112:127], v[52:55], v[60:63], v[112:127]
    s_waitcnt lgkmcnt(0)
    v_mfma_f32_32x32x16_bf16 v[64:79], v[32:35], v[40:43], v[64:79]
    ds_read_b128 v[48:51], v131 offset:0
    ds_read_b64_tr_b16 v[56:57], v140 offset:6144
    ds_read_b64_tr_b16 v[58:59], v140 offset:6656
    v_mfma_f32_32x32x16_bf16 v[80:95], v[32:35], v[44:47], v[80:95]
    ds_read_b64_tr_b16 v[60:61], v141 offset:6144
    ds_read_b64_tr_b16 v[62:63], v141 offset:6656
    ds_read_b128 v[52:55], v131 offset:4096
    v_mfma_f32_32x32x16_bf16 v[96:111], v[36:39], v[40:43], v[96:111]
    v_mfma_f32_32x32x16_bf16 v[112:127], v[36:39], v[44:47], v[112:127]
    s_waitcnt lgkmcnt(0)
    v_mfma_f32_32x32x16_bf16 v[64:79], v[48:51], v[56:59], v[64:79]
    s_barrier
    ds_read_b128 v[32:35], v128 offset:32768
    ds_read_b64_tr_b16 v[40:41], v140 offset:32768
    ds_read_b64_tr_b16 v[42:43], v140 offset:33280
    v_mfma_f32_32x32x16_bf16 v[80:95], v[48:51], v[60:63], v[80:95]
    ds_read_b64_tr_b16 v[44:45], v141 offset:32768
    ds_read_b64_tr_b16 v[46:47], v141 offset:33280
    ds_read_b128 v[36:39], v128 offset:36864
    v_mfma_f32_32x32x16_bf16 v[96:111], v[52:55], v[56:59], v[96:111]
    v_mfma_f32_32x32x16_bf16 v[112:127], v[52:55], v[60:63], v[112:127]
    s_waitcnt lgkmcnt(0)
    v_mfma_f32_32x32x16_bf16 v[64:79], v[32:35], v[40:43], v[64:79]
    ds_read_b128 v[48:51], v129 offset:32768
    ds_read_b64_tr_b16 v[56:57], v140 offset:34816
    ds_read_b64_tr_b16 v[58:59], v140 offset:35328
    v_mfma_f32_32x32x16_bf16 v[80:95], v[32:35], v[44:47], v[80:95]
    ds_read_b64_tr_b16 v[60:61], v141 offset:34816
    ds_read_b64_tr_b16 v[62:63], v141 offset:35328
    ds_read_b128 v[52:55], v129 offset:36864
    v_mfma_f32_32x32x16_bf16 v[96:111], v[36:39], v[40:43], v[96:111]
    v_mfma_f32_32x32x16_bf16 v[112:127], v[36:39], v[44:47], v[112:127]
    s_waitcnt lgkmcnt(0)
    v_mfma_f32_32x32x16_bf16 v[64:79], v[48:51], v[56:59], v[64:79]
    ds_read_b128 v[32:35], v130 offset:32768
    ds_read_b64_tr_b16 v[40:41], v140 offset:36864
    ds_read_b64_tr_b16 v[42:43], v140 offset:37376
    v_mfma_f32_32x32x16_bf16 v[80:95], v[48:51], v[60:63], v[80:95]
    ds_read_b64_tr_b16 v[44:45], v141 offset:36864
    ds_read_b64_tr_b16 v[46:47], v141 offset:37376
    ds_read_b128 v[36:39], v130 offset:36864
    v_mfma_f32_32x32x16_bf16 v[96:111], v[52:55], v[56:59], v[96:111]
    v_mfma_f32_32x32x16_bf16 v[112:127], v[52:55], v[60:63], v[112:127]
    s_waitcnt lgkmcnt(0)
    v_mfma_f32_32x32x16_bf16 v[64:79], v[32:35], v[40:43], v[64:79]
    ds_read_b128 v[48:51], v131 offset:32768
    ds_read_b64_tr_b16 v[56:57], v140 offset:38912
    ds_read_b64_tr_b16 v[58:59], v140 offset:39424
    v_mfma_f32_32x32x16_bf16 v[80:95], v[32:35], v[44:47], v[80:95]
    ds_read_b64_tr_b16 v[60:61], v141 offset:38912
    ds_read_b64_tr_b16 v[62:63], v141 offset:39424
    ds_read_b128 v[52:55], v131 offset:36864
    v_mfma_f32_32x32x16_bf16 v[96:111], v[36:39], v[40:43], v[96:111]
    v_mfma_f32_32x32x16_bf16 v[112:127], v[36:39], v[44:47], v[112:127]
    s_waitcnt lgkmcnt(0)
    v_mfma_f32_32x32x16_bf16 v[64:79], v[48:51], v[56:59], v[64:79]
    s_barrier
    ds_read_b128 v[192:195], v132 offset:0
    ds_read_b64_tr_b16 v[200:201], v142 offset:0
    ds_read_b64_tr_b16 v[202:203], v142 offset:512
    v_mfma_f32_32x32x16_bf16 v[80:95], v[48:51], v[60:63], v[80:95]
    ds_read_b128 v[208:211], v133 offset:0
    ds_read_b64_tr_b16 v[216:217], v142 offset:2048
    ds_read_b64_tr_b16 v[218:219], v142 offset:2560
    v_mfma_f32_32x32x16_bf16 v[96:111], v[52:55], v[56:59], v[96:111]
    ds_read_b128 v[224:227], v134 offset:0
    ds_read_b64_tr_b16 v[232:233], v142 offset:4096
    ds_read_b64_tr_b16 v[234:235], v142 offset:4608
    v_mfma_f32_32x32x16_bf16 v[112:127], v[52:55], v[60:63], v[112:127]
    s_waitcnt lgkmcnt(8)
    s_waitcnt lgkmcnt(6)
    v_mfma_f32_32x32x16_bf16 v[64:79], v[192:195], v[200:203], v[64:79]
    ds_read_b128 v[240:243], v135 offset:0
    ds_read_b64_tr_b16 v[248:249], v142 offset:6144
    ds_read_b64_tr_b16 v[250:251], v142 offset:6656
    ds_read_b64_tr_b16 v[204:205], v143 offset:0
    s_waitcnt lgkmcnt(9)
    s_waitcnt lgkmcnt(7)
    v_mfma_f32_32x32x16_bf16 v[64:79], v[208:211], v[216:219], v[64:79]
    ds_read_b64_tr_b16 v[206:207], v143 offset:512
    ds_read_b64_tr_b16 v[220:221], v143 offset:2048
    ds_read_b64_tr_b16 v[222:223], v143 offset:2560
    ds_read_b64_tr_b16 v[236:237], v143 offset:4096
    s_waitcnt lgkmcnt(10)
    s_waitcnt lgkmcnt(8)
    v_mfma_f32_32x32x16_bf16 v[64:79], v[224:227], v[232:235], v[64:79]
    ds_read_b64_tr_b16 v[238:239], v143 offset:4608
    ds_read_b64_tr_b16 v[252:253], v143 offset:6144
    ds_read_b64_tr_b16 v[254:255], v143 offset:6656
    ds_read_b128 v[196:199], v132 offset:4096
    s_waitcnt lgkmcnt(11)
    s_waitcnt lgkmcnt(9)
    v_mfma_f32_32x32x16_bf16 v[64:79], v[240:243], v[248:251], v[64:79]
    ds_read_b128 v[212:215], v133 offset:4096
    ds_read_b128 v[228:231], v134 offset:4096
    ds_read_b128 v[244:247], v135 offset:4096
    s_waitcnt lgkmcnt(10)
    v_mfma_f32_32x32x16_bf16 v[80:95], v[192:195], v[204:207], v[80:95]
    s_waitcnt lgkmcnt(8)
    v_mfma_f32_32x32x16_bf16 v[80:95], v[208:211], v[220:223], v[80:95]
    s_waitcnt lgkmcnt(6)
    v_mfma_f32_32x32x16_bf16 v[80:95], v[224:227], v[236:239], v[80:95]
    s_waitcnt lgkmcnt(4)
    v_mfma_f32_32x32x16_bf16 v[80:95], v[240:243], v[252:255], v[80:95]
    s_nop 0
    v_cvt_pk_bf16_f32 v160, v64, v65
    v_cvt_pk_bf16_f32 v161, v66, v67
    v_cvt_pk_bf16_f32 v162, v68, v69
    s_waitcnt lgkmcnt(3)
    v_mfma_f32_32x32x16_bf16 v[112:127], v[196:199], v[204:207], v[112:127]
    v_cvt_pk_bf16_f32 v163, v70, v71
    buffer_store_dwordx4 v[160:163], v146, s[20:23], 0 offen offset:0 sc1
    v_cvt_pk_bf16_f32 v164, v72, v73
    s_waitcnt lgkmcnt(2)
    v_mfma_f32_32x32x16_bf16 v[112:127], v[212:215], v[220:223], v[112:127]
    v_cvt_pk_bf16_f32 v165, v74, v75
    v_cvt_pk_bf16_f32 v166, v76, v77
    v_cvt_pk_bf16_f32 v167, v78, v79
    s_waitcnt lgkmcnt(1)
    v_mfma_f32_32x32x16_bf16 v[112:127], v[228:231], v[236:239], v[112:127]
    buffer_store_dwordx4 v[164:167], v146, s[20:23], 0 offen offset:1024 sc1
    v_cvt_pk_bf16_f32 v168, v80, v81
    v_cvt_pk_bf16_f32 v169, v82, v83
    s_waitcnt lgkmcnt(0)
    v_mfma_f32_32x32x16_bf16 v[112:127], v[244:247], v[252:255], v[112:127]
    s_mov_b64 exec, 1
    ds_add_u32 v17, v16 offset:8
    s_mov_b64 exec, -1
    v_cvt_pk_bf16_f32 v170, v84, v85
    v_cvt_pk_bf16_f32 v171, v86, v87
    buffer_store_dwordx4 v[168:171], v147, s[20:23], 0 offen offset:0 sc1
    v_mfma_f32_32x32x16_bf16 v[96:111], v[196:199], v[200:203], v[96:111]
    v_cvt_pk_bf16_f32 v172, v88, v89
    v_cvt_pk_bf16_f32 v173, v90, v91
    v_cvt_pk_bf16_f32 v174, v92, v93
    v_mfma_f32_32x32x16_bf16 v[96:111], v[212:215], v[216:219], v[96:111]
    v_cvt_pk_bf16_f32 v175, v94, v95
    buffer_store_dwordx4 v[172:175], v147, s[20:23], 0 offen offset:1024 sc1
    v_cvt_pk_bf16_f32 v184, v112, v113
    v_mfma_f32_32x32x16_bf16 v[96:111], v[228:231], v[232:235], v[96:111]
    v_cvt_pk_bf16_f32 v185, v114, v115
    v_cvt_pk_bf16_f32 v186, v116, v117
    v_cvt_pk_bf16_f32 v187, v118, v119
    v_mfma_f32_32x32x16_bf16 v[96:111], v[244:247], v[248:251], v[96:111]
    buffer_store_dwordx4 v[184:187], v147, s[20:23], 0 offen offset:2048 sc1
    v_cvt_pk_bf16_f32 v188, v120, v121
    v_cvt_pk_bf16_f32 v189, v122, v123
    v_cvt_pk_bf16_f32 v190, v124, v125
    v_cvt_pk_bf16_f32 v191, v126, v127
    buffer_store_dwordx4 v[188:191], v147, s[20:23], 0 offen offset:3072 sc1
    s_nop 8
    v_cvt_pk_bf16_f32 v176, v96, v97
    v_cvt_pk_bf16_f32 v177, v98, v99
    v_cvt_pk_bf16_f32 v178, v100, v101
    v_cvt_pk_bf16_f32 v179, v102, v103
    buffer_store_dwordx4 v[176:179], v146, s[20:23], 0 offen offset:2048 sc1
    v_cvt_pk_bf16_f32 v180, v104, v105
    v_cvt_pk_bf16_f32 v181, v106, v107
    v_cvt_pk_bf16_f32 v182, v108, v109
    v_cvt_pk_bf16_f32 v183, v110, v111
    buffer_store_dwordx4 v[180:183], v146, s[20:23], 0 offen offset:3072 sc1
    s_branch L_m_join
L_m_gate:
    s_mov_b32 s4, s40
    s_mov_b32 s5, s41
    s_mov_b32 s6, 1835008
    s_mov_b32 s7, 0x20000
    s_mov_b32 s8, s52
    s_mov_b32 s9, s53
    s_mov_b32 s10, 896
    s_mov_b32 s11, 0x20000
    s_lshl_b32 s75, s61, 7
    s_sub_u32 s76, s62, 14
    s_lshl_b32 s76, s76, 6
    s_add_u32 s75, s75, s76
    s_lshl_b32 s76, s3, 4
    s_add_u32 s75, s75, s76
    v_lshrrev_b32 v2, 3, v1
    v_add_u32 v2, s75, v2
    v_and_b32 v3, 7, v1
    v_lshlrev_b32 v3, 4, v3
    v_mul_u32_u24 v4, 896, v2
    v_add_u32 v4, v4, v3
    v_add_u32 v5, 7168, v4
    buffer_load_dwordx4 v[64:67], v3, s[8:11], 0 offen offset:0
    buffer_load_dwordx4 v[96:99], v4, s[4:7], 0 offen offset:0
    buffer_load_dwordx4 v[128:131], v5, s[4:7], 0 offen offset:0
    buffer_load_dwordx4 v[68:71], v3, s[8:11], 0 offen offset:128
    buffer_load_dwordx4 v[100:103], v4, s[4:7], 0 offen offset:128
    buffer_load_dwordx4 v[132:135], v5, s[4:7], 0 offen offset:128
    buffer_load_dwordx4 v[72:75], v3, s[8:11], 0 offen offset:256
    buffer_load_dwordx4 v[104:107], v4, s[4:7], 0 offen offset:256
    buffer_load_dwordx4 v[136:139], v5, s[4:7], 0 offen offset:256
    buffer_load_dwordx4 v[76:79], v3, s[8:11], 0 offen offset:384
    buffer_load_dwordx4 v[108:111], v4, s[4:7], 0 offen offset:384
    buffer_load_dwordx4 v[140:143], v5, s[4:7], 0 offen offset:384
    buffer_load_dwordx4 v[80:83], v3, s[8:11], 0 offen offset:512
    buffer_load_dwordx4 v[112:115], v4, s[4:7], 0 offen offset:512
    buffer_load_dwordx4 v[144:147], v5, s[4:7], 0 offen offset:512
    buffer_load_dwordx4 v[84:87], v3, s[8:11], 0 offen offset:640
    buffer_load_dwordx4 v[116:119], v4, s[4:7], 0 offen offset:640
    buffer_load_dwordx4 v[148:151], v5, s[4:7], 0 offen offset:640
    buffer_load_dwordx4 v[88:91], v3, s[8:11], 0 offen offset:768
    buffer_load_dwordx4 v[120:123], v4, s[4:7], 0 offen offset:768
    buffer_load_dwordx4 v[152:155], v5, s[4:7], 0 offen offset:768
    v_mov_b32 v6, 0
    v_mov_b32 v7, 0
    v_lshlrev_b32 v2, 2, v2
    v_add_u32 v2, 16515072, v2
    v_mov_b32 v8, 1073741824
    v_cmp_eq_u32 vcc, 0, v3
    s_nop 1
    v_cndmask_b32 v9, v8, v2, vcc
    s_waitcnt lgkmcnt(0)
    s_add_u32 s60, s60, 0x9e3779b1
    v_mov_b32 v30, s60
    s_barrier
    s_mov_b64 exec, 1
    ds_add_u32 v17, v16 offset:8
    s_mov_b64 exec, -1
    s_waitcnt vmcnt(0)
    s_lshl_b32 s75, s61, 1
    s_add_u32 s75, s75, s62
    s_sub_u32 s75, s75, 14
    s_lshl_b32 s75, s75, 3
    s_add_u32 s75, s75, s3
    s_add_u32 s75, s75, 0
    s_mul_i32 s75, s75, 13
    v_add_u32 v11, s75, v1
    v_min_u32 v11, 3135, v11
    v_lshlrev_b32 v11, 7, v11
    s_mov_b64 exec, 0x1fff
    global_load_dword v18, v11, s[44:45]
    global_load_dword v18, v11, s[50:51]
    s_mov_b64 exec, -1
    v_dot2_f32_bf16 v6, v64, v96, v6
    v_dot2_f32_bf16 v7, v64, v128, v7
    v_dot2_f32_bf16 v6, v65, v97, v6
    v_dot2_f32_bf16 v7, v65, v129, v7
    v_dot2_f32_bf16 v6, v66, v98, v6
    v_dot2_f32_bf16 v7, v66, v130, v7
    v_dot2_f32_bf16 v6, v67, v99, v6
    v_dot2_f32_bf16 v7, v67, v131, v7
    v_dot2_f32_bf16 v6, v68, v100, v6
    v_dot2_f32_bf16 v7, v68, v132, v7
    v_dot2_f32_bf16 v6, v69, v101, v6
    v_dot2_f32_bf16 v7, v69, v133, v7
    v_dot2_f32_bf16 v6, v70, v102, v6
    v_dot2_f32_bf16 v7, v70, v134, v7
    v_dot2_f32_bf16 v6, v71, v103, v6
    v_dot2_f32_bf16 v7, v71, v135, v7
    v_dot2_f32_bf16 v6, v72, v104, v6
    v_dot2_f32_bf16 v7, v72, v136, v7
    v_dot2_f32_bf16 v6, v73, v105, v6
    v_dot2_f32_bf16 v7, v73, v137, v7
    v_dot2_f32_bf16 v6, v74, v106, v6
    v_dot2_f32_bf16 v7, v74, v138, v7
    v_dot2_f32_bf16 v6, v75, v107, v6
    v_dot2_f32_bf16 v7, v75, v139, v7
    v_dot2_f32_bf16 v6, v76, v108, v6
    v_dot2_f32_bf16 v7, v76, v140, v7
    v_dot2_f32_bf16 v6, v77, v109, v6
    v_dot2_f32_bf16 v7, v77, v141, v7
    v_dot2_f32_bf16 v6, v78, v110, v6
    v_dot2_f32_bf16 v7, v78, v142, v7
    v_dot2_f32_bf16 v6, v79, v111, v6
    v_dot2_f32_bf16 v7, v79, v143, v7
    v_dot2_f32_bf16 v6, v80, v112, v6
    v_dot2_f32_bf16 v7, v80, v144, v7
    v_dot2_f32_bf16 v6, v81, v113, v6
    v_dot2_f32_bf16 v7, v81, v145, v7
    v_dot2_f32_bf16 v6, v82, v114, v6
    v_dot2_f32_bf16 v7, v82, v146, v7
    v_dot2_f32_bf16 v6, v83, v115, v6
    v_dot2_f32_bf16 v7, v83, v147, v7
    v_dot2_f32_bf16 v6, v84, v116, v6
    v_dot2_f32_bf16 v7, v84, v148, v7
    v_dot2_f32_bf16 v6, v85, v117, v6
    v_dot2_f32_bf16 v7, v85, v149, v7
    v_dot2_f32_bf16 v6, v86, v118, v6
    v_dot2_f32_bf16 v7, v86, v150, v7
    v_dot2_f32_bf16 v6, v87, v119, v6
    v_dot2_f32_bf16 v7, v87, v151, v7
    v_dot2_f32_bf16 v6, v88, v120, v6
    v_dot2_f32_bf16 v7, v88, v152, v7
    v_dot2_f32_bf16 v6, v89, v121, v6
    v_dot2_f32_bf16 v7, v89, v153, v7
    v_dot2_f32_bf16 v6, v90, v122, v6
    v_dot2_f32_bf16 v7, v90, v154, v7
    v_dot2_f32_bf16 v6, v91, v123, v6
    v_dot2_f32_bf16 v7, v91, v155, v7
    s_nop 2
    v_add_f32_dpp v6, v6, v6 quad_perm:[1,0,3,2] row_mask:0xf bank_mask:0xf
    v_add_f32_dpp v7, v7, v7 quad_perm:[1,0,3,2] row_mask:0xf bank_mask:0xf
    s_nop 1
    v_add_f32_dpp v6, v6, v6 quad_perm:[2,3,0,1] row_mask:0xf bank_mask:0xf
    v_add_f32_dpp v7, v7, v7 quad_perm:[2,3,0,1] row_mask:0xf bank_mask:0xf
    s_nop 1
    v_add_f32_dpp v6, v6, v6 row_half_mirror row_mask:0xf bank_mask:0xf
    v_add_f32_dpp v7, v7, v7 row_half_mirror row_mask:0xf bank_mask:0xf
    s_nop 1
    v_mul_f32 v6, 0xbfb8aa3b, v6
    v_exp_f32 v6, v6
    s_nop 0
    v_add_f32 v6, 1.0, v6
    v_rcp_f32 v6, v6
    s_nop 0
    v_mul_f32 v7, 0xbfb8aa3b, v7
    v_exp_f32 v7, v7
    s_nop 0
    v_add_f32 v7, 1.0, v7
    v_rcp_f32 v7, v7
    s_nop 0
    buffer_store_dword v6, v9, s[20:23], 0 offen sc1
    buffer_store_dword v7, v9, s[20:23], 0 offen offset:32 sc1
L_m_join:
    s_add_u32 s73, s70, 7
    s_lshr_b32 s73, s73, 1
    s_add_u32 s74, s71, 7
    s_lshr_b32 s74, s74, 1
    s_add_u32 s75, s70, 14
    s_lshr_b32 s75, s75, 1
    s_add_u32 s76, s71, 14
    s_lshr_b32 s76, s76, 1
    s_lshr_b32 s77, s70, 1
    s_lshr_b32 s78, s71, 1
    s_lshr_b32 s83, s3, 1
    s_add_u32 s83, s83, 14
    v_mov_b32 v2, s73
    v_cmp_le_u32 vcc, 4, v1
    v_mov_b32 v3, s74
    s_nop 0
    v_cndmask_b32 v2, v2, v3, vcc
    v_cmp_le_u32 vcc, 8, v1
    v_mov_b32 v3, s75
    s_nop 0
    v_cndmask_b32 v2, v2, v3, vcc
    v_cmp_le_u32 vcc, 12, v1
    v_mov_b32 v3, s76
    s_nop 0
    v_cndmask_b32 v2, v2, v3, vcc
    v_cmp_le_u32 vcc, 16, v1
    v_mov_b32 v3, s77
    s_nop 0
    v_cndmask_b32 v2, v2, v3, vcc
    v_cmp_le_u32 vcc, 17, v1
    v_mov_b32 v3, s78
    s_nop 0
    v_cndmask_b32 v2, v2, v3, vcc
    v_cmp_le_u32 vcc, 18, v1
    v_mov_b32 v3, s83
    s_nop 0
    v_cndmask_b32 v2, v2, v3, vcc
    s_lshl_b32 s73, s3, 2
    v_and_b32 v3, 3, v1
    v_add_u32 v3, s73, v3
    v_mov_b32 v4, s64
    v_cmp_le_u32 vcc, 16, v1
    s_nop 1
    v_cndmask_b32 v3, v3, v4, vcc
    v_lshl_add_u32 v2, v2, 4, v3
    v_lshlrev_b32 v2, 7, v2
    v_add_u32 v28, 16547840, v2
    s_lshl_b32 s73, s65, 9
    s_mul_i32 s74, s3, 1376256
    s_add_u32 s74, s74, s73
    s_add_u32 s74, s74, 28672
    v_add_u32 v26, s74, v0
    s_lshl_b32 s74, s63, 17
    s_lshl_b32 s75, s3, 15
    s_add_u32 s74, s74, s75
    s_add_u32 s74, s74, 5505024
    v_add_u32 v25, s74, v0
    s_mul_i32 s74, s64, 344064
    s_add_u32 s74, s74, s73
    v_add_u32 v24, s74, v0
    s_cmp_eq_u32 s66, 0
    s_mov_b32 s86, 0
    s_cselect_b32 s87, -1, 0
    s_cselect_b32 s88, 0, -1
    s_mov_b32 s89, 0
    v_mov_b32 v22, 0xdddddddd
    s_add_u32 s73, s3, 1
    s_and_b32 s73, s73, 3
    s_mul_i32 s73, s73, 12288
    s_add_u32 s73, s73, 106496
    v_add_u32 v12, s73, v0
    s_add_u32 s73, s3, 2
    s_and_b32 s73, s73, 3
    s_mul_i32 s73, s73, 12288
    s_add_u32 s73, s73, 110592
    v_add_u32 v13, s73, v0
    s_add_u32 s73, s3, 3
    s_and_b32 s73, s73, 3
    s_mul_i32 s73, s73, 12288
    s_add_u32 s73, s73, 114688
    v_add_u32 v14, s73, v0
    s_mul_i32 s73, s3, 12288
    s_add_u32 s73, s73, 106496
    v_add_u32 v15, s73, v0
    s_lshl_b32 s73, s64, 2
    s_add_u32 s73, s73, s3
    s_lshl_b32 s73, s73, 4
    s_add_u32 s73, s73, s63
    s_lshl_b32 s73, s73, 7
    s_add_u32 s73, s73, 17301504
    v_mov_b32 v2, 1073741824
    v_mov_b32 v3, s73
    v_cndmask_b32 v11, v2, v3, s[90:91]
    v_mov_b32 v128, 0
    v_mov_b32 v129, 0
    v_mov_b32 v130, 0
    v_mov_b32 v131, 0
    v_mov_b32 v132, 0
    v_mov_b32 v133, 0
    v_mov_b32 v134, 0
    v_mov_b32 v135, 0
    v_mov_b32 v136, 0
    v_mov_b32 v137, 0
    v_mov_b32 v138, 0
    v_mov_b32 v139, 0
    v_mov_b32 v140, 0
    v_mov_b32 v141, 0
    v_mov_b32 v142, 0
    v_mov_b32 v143, 0
    v_mov_b32 v144, 0
    v_mov_b32 v145, 0
    v_mov_b32 v146, 0
    v_mov_b32 v147, 0
    v_mov_b32 v148, 0
    v_mov_b32 v149, 0
    v_mov_b32 v150, 0
    v_mov_b32 v151, 0
    v_mov_b32 v152, 0
    v_mov_b32 v153, 0
    v_mov_b32 v154, 0
    v_mov_b32 v155, 0
    v_mov_b32 v156, 0
    v_mov_b32 v157, 0
    v_mov_b32 v158, 0
    v_mov_b32 v159, 0
    v_mov_b32 v160, 0
    v_mov_b32 v161, 0
    v_mov_b32 v162, 0
    v_mov_b32 v163, 0
    v_mov_b32 v164, 0
    v_mov_b32 v165, 0
    v_mov_b32 v166, 0
    v_mov_b32 v167, 0
    v_mov_b32 v168, 0
    v_mov_b32 v169, 0
    v_mov_b32 v170, 0
    v_mov_b32 v171, 0
    v_mov_b32 v172, 0
    v_mov_b32 v173, 0
    v_mov_b32 v174, 0
    v_mov_b32 v175, 0
    v_mov_b32 v176, 0
    v_mov_b32 v177, 0
    v_mov_b32 v178, 0
    v_mov_b32 v179, 0
    v_mov_b32 v180, 0
    v_mov_b32 v181, 0
    v_mov_b32 v182, 0
    v_mov_b32 v183, 0
    v_mov_b32 v184, 0
    v_mov_b32 v185, 0
    v_mov_b32 v186, 0
    v_mov_b32 v187, 0
    v_mov_b32 v188, 0
    v_mov_b32 v189, 0
    v_mov_b32 v190, 0
    v_mov_b32 v191, 0
    s_add_u32 s73, s3, 1
    s_and_b32 s73, s73, 3
    s_mul_i32 s74, s73, 86016
    s_add_u32 s73, s3, 2
    s_and_b32 s73, s73, 3
    s_mul_i32 s75, s73, 86016
    s_add_u32 s73, s3, 3
    s_and_b32 s73, s73, 3
    s_mul_i32 s76, s73, 86016
    s_add_u32 s73, s3, 4
    s_and_b32 s73, s73, 3
    s_mul_i32 s77, s73, 86016
    s_setprio 1
    s_waitcnt vmcnt(0)
    s_mov_b64 exec, 1
    ds_add_rtn_u32 v2, v17, v16 offset:0
    s_mov_b64 exec, -1
    s_waitcnt lgkmcnt(0)
    v_readfirstlane_b32 s83, v2
    s_cmp_lg_u32 s83, 3
    s_cbranch_scc1 L_nopub_34
    s_add_u32 s73, s97, 16547840
    v_mov_b32 v2, 1073741824
    v_mov_b32 v3, s73
    v_cndmask_b32 v29, v2, v3, s[90:91]
    buffer_store_dword v30, v29, s[20:23], 0 offen sc1
L_nopub_34:
    s_sleep 20
    buffer_load_dword v4, v28, s[20:23], 0 offen sc1
L_pp_35:
    s_sleep 2
    buffer_load_dword v5, v28, s[20:23], 0 offen sc1
    s_waitcnt vmcnt(1)
    v_cmp_ne_u32 vcc, s60, v4
    s_cmp_eq_u64 vcc, 0
    s_cbranch_scc1 L_ppd_36
    s_sleep 2
    buffer_load_dword v4, v28, s[20:23], 0 offen sc1
    s_waitcnt vmcnt(1)
    v_cmp_ne_u32 vcc, s60, v5
    s_cmp_eq_u64 vcc, 0
    s_cbranch_scc1 L_ppd_36
    s_sub_u32 s79, s79, 1
    s_cbranch_scc0 L_pp_35
    s_mov_b32 s79, 0
L_ppd_36:
    s_mov_b32 s92, 0
    s_mov_b32 s93, 0
    buffer_load_dwordx4 v[192:195], v26, s[20:23], s92 offen offset:0 sc1
    buffer_load_dwordx4 v[196:199], v26, s[20:23], s92 offen offset:1024 sc1
    buffer_load_dwordx4 v[32:35], v24, s[20:23], s74 offen offset:0 sc1
    buffer_load_dwordx4 v[36:39], v24, s[20:23], s74 offen offset:1024 sc1
    buffer_load_dwordx4 v[40:43], v24, s[20:23], s75 offen offset:0 sc1
    buffer_load_dwordx4 v[44:47], v24, s[20:23], s75 offen offset:1024 sc1
    buffer_load_dwordx4 v[200:203], v25, s[20:23], s93 offen offset:0 sc1
    buffer_load_dwordx4 v[204:207], v25, s[20:23], s93 offen offset:1024 sc1
    buffer_load_dwordx4 v[48:51], v24, s[20:23], s76 offen offset:0 sc1
    buffer_load_dwordx4 v[52:55], v24, s[20:23], s76 offen offset:1024 sc1
    buffer_load_dwordx4 v[56:59], v24, s[20:23], s77 offen offset:0 sc1
    buffer_load_dwordx4 v[60:63], v24, s[20:23], s77 offen offset:1024 sc1
    s_mov_b32 s92, 86016
    s_mov_b32 s93, 2048
    buffer_load_dwordx4 v[208:211], v26, s[20:23], s92 offen offset:0 sc1
    buffer_load_dwordx4 v[212:215], v26, s[20:23], s92 offen offset:1024 sc1
    buffer_load_dwordx4 v[216:219], v25, s[20:23], s93 offen offset:0 sc1
    buffer_load_dwordx4 v[220:223], v25, s[20:23], s93 offen offset:1024 sc1
    s_lshl_b32 s73, s64, 2
    s_add_u32 s73, s73, s3
    s_lshl_b32 s73, s73, 7
    s_add_u32 s73, s73, 16515072
    v_and_b32 v2, 31, v1
    v_lshlrev_b32 v2, 2, v2
    buffer_load_dword v23, v2, s[20:23], s73 offen sc1
    s_mov_b64 exec, 1
    ds_add_u32 v17, v16 offset:60
    s_mov_b64 exec, -1
    s_mov_b32 s77, 8
    s_waitcnt vmcnt(13)
    v_cndmask_b32 v32, v32, v27, s[88:89]
    v_cndmask_b32 v33, v33, v27, s[88:89]
    v_cndmask_b32 v38, v38, v27, s[86:87]
    v_cndmask_b32 v39, v39, v27, s[86:87]
    s_nop 0
    v_mfma_f32_32x32x16_bf16 v[64:79], v[192:195], v[32:35], 0
    v_mfma_f32_32x32x16_bf16 v[64:79], v[196:199], v[36:39], v[64:79]
    s_waitcnt vmcnt(11)
    v_cndmask_b32 v40, v40, v27, s[88:89]
    v_cndmask_b32 v41, v41, v27, s[88:89]
    v_cndmask_b32 v46, v46, v27, s[86:87]
    v_cndmask_b32 v47, v47, v27, s[86:87]
    s_nop 5
    v_mfma_f32_32x32x16_bf16 v[80:95], v[192:195], v[40:43], 0
    s_mov_b32 s92, 172032
    v_exp_f32 v64, v64
    v_exp_f32 v65, v65
    v_exp_f32 v66, v66
    v_exp_f32 v67, v67
    v_mfma_f32_32x32x16_bf16 v[80:95], v[196:199], v[44:47], v[80:95]
    s_waitcnt vmcnt(9)
    v_exp_f32 v68, v68
    v_exp_f32 v69, v69
    v_exp_f32 v70, v70
    v_exp_f32 v71, v71
    buffer_load_dwordx4 v[224:227], v26, s[20:23], s92 offen offset:0 sc1
    v_exp_f32 v72, v72
    v_exp_f32 v73, v73
    v_exp_f32 v74, v74
    v_exp_f32 v75, v75
    v_smfmac_f32_32x32x32_bf16 v[128:143], v[200:203], v[64:71], v22
    buffer_load_dwordx4 v[228:231], v26, s[20:23], s92 offen offset:1024 sc1
    s_waitcnt vmcnt(9)
    v_exp_f32 v76, v76
    v_exp_f32 v77, v77
    v_exp_f32 v78, v78
    v_exp_f32 v79, v79
    v_cndmask_b32 v48, v48, v27, s[88:89]
    v_cndmask_b32 v49, v49, v27, s[88:89]
    v_cndmask_b32 v54, v54, v27, s[86:87]
    v_cndmask_b32 v55, v55, v27, s[86:87]
    v_mfma_f32_32x32x16_bf16 v[96:111], v[192:195], v[48:51], 0
    s_mov_b32 s93, 4096
    v_exp_f32 v80, v80
    v_exp_f32 v81, v81
    v_exp_f32 v82, v82
    v_exp_f32 v83, v83
    v_mfma_f32_32x32x16_bf16 v[96:111], v[196:199], v[52:55], v[96:111]
    v_exp_f32 v84, v84
    v_exp_f32 v85, v85
    v_exp_f32 v86, v86
    v_exp_f32 v87, v87
    v_smfmac_f32_32x32x32_bf16 v[128:143], v[204:207], v[72:79], v22
    buffer_load_dwordx4 v[232:235], v25, s[20:23], s93 offen offset:0 sc1
    v_exp_f32 v88, v88
    v_exp_f32 v89, v89
    v_exp_f32 v90, v90
    v_exp_f32 v91, v91
    v_smfmac_f32_32x32x32_bf16 v[144:159], v[200:203], v[80:87], v22
    buffer_load_dwordx4 v[236:239], v25, s[20:23], s93 offen offset:1024 sc1
    s_waitcnt vmcnt(9)
    v_exp_f32 v92, v92
    v_exp_f32 v93, v93
    v_exp_f32 v94, v94
    v_exp_f32 v95, v95
    v_cndmask_b32 v56, v56, v27, s[88:89]
    v_cndmask_b32 v57, v57, v27, s[88:89]
    v_cndmask_b32 v62, v62, v27, s[86:87]
    v_cndmask_b32 v63, v63, v27, s[86:87]
    v_mfma_f32_32x32x16_bf16 v[112:127], v[192:195], v[56:59], 0
    s_mov_b32 s92, 258048
    v_exp_f32 v96, v96
    v_exp_f32 v97, v97
    v_exp_f32 v98, v98
    v_exp_f32 v99, v99
    v_mfma_f32_32x32x16_bf16 v[112:127], v[196:199], v[60:63], v[112:127]
    v_exp_f32 v100, v100
    v_exp_f32 v101, v101
    v_exp_f32 v102, v102
    v_exp_f32 v103, v103
    v_smfmac_f32_32x32x32_bf16 v[144:159], v[204:207], v[88:95], v22
    buffer_load_dwordx4 v[240:243], v26, s[20:23], s92 offen offset:0 sc1
    v_exp_f32 v104, v104
    v_exp_f32 v105, v105
    v_exp_f32 v106, v106
    v_exp_f32 v107, v107
    v_smfmac_f32_32x32x32_bf16 v[160:175], v[200:203], v[96:103], v22
    buffer_load_dwordx4 v[244:247], v26, s[20:23], s92 offen offset:1024 sc1
    s_waitcnt vmcnt(9)
    v_exp_f32 v108, v108
    v_exp_f32 v109, v109
    v_exp_f32 v110, v110
    v_exp_f32 v111, v111
    v_mfma_f32_32x32x16_bf16 v[64:79], v[208:211], v[32:35], 0
    s_mov_b32 s93, 6144
    v_exp_f32 v112, v112
    v_exp_f32 v113, v113
    v_exp_f32 v114, v114
    v_exp_f32 v115, v115
    v_mfma_f32_32x32x16_bf16 v[64:79], v[212:215], v[36:39], v[64:79]
    v_exp_f32 v116, v116
    v_exp_f32 v117, v117
    v_exp_f32 v118, v118
    v_exp_f32 v119, v119
    v_smfmac_f32_32x32x32_bf16 v[160:175], v[204:207], v[104:111], v22
    buffer_load_dwordx4 v[248:251], v25, s[20:23], s93 offen offset:0 sc1
    v_exp_f32 v120, v120
    v_exp_f32 v121, v121
    v_exp_f32 v122, v122
    v_exp_f32 v123, v123
    v_smfmac_f32_32x32x32_bf16 v[176:191], v[200:203], v[112:119], v22
    buffer_load_dwordx4 v[252:255], v25, s[20:23], s93 offen offset:1024 sc1
    s_waitcnt vmcnt(9)
    v_exp_f32 v124, v124
    v_exp_f32 v125, v125
    v_exp_f32 v126, v126
    v_exp_f32 v127, v127
    v_mfma_f32_32x32x16_bf16 v[80:95], v[208:211], v[40:43], 0
    s_mov_b32 s92, 344064
    v_exp_f32 v64, v64
    v_exp_f32 v65, v65
    v_exp_f32 v66, v66
    v_exp_f32 v67, v67
    v_mfma_f32_32x32x16_bf16 v[80:95], v[212:215], v[44:47], v[80:95]
    v_exp_f32 v68, v68
    v_exp_f32 v69, v69
    v_exp_f32 v70, v70
    v_exp_f32 v71, v71
    v_smfmac_f32_32x32x32_bf16 v[176:191], v[204:207], v[120:127], v22
    buffer_load_dwordx4 v[192:195], v26, s[20:23], s92 offen offset:0 sc1
    v_exp_f32 v72, v72
    v_exp_f32 v73, v73
    v_exp_f32 v74, v74
    v_exp_f32 v75, v75
    v_smfmac_f32_32x32x32_bf16 v[128:143], v[216:219], v[64:71], v22
    v_exp_f32 v76, v76
    v_exp_f32 v77, v77
    v_exp_f32 v78, v78
    v_exp_f32 v79, v79
    v_mfma_f32_32x32x16_bf16 v[96:111], v[208:211], v[48:51], 0
    v_exp_f32 v80, v80
    v_exp_f32 v81, v81
    v_exp_f32 v82, v82
    v_exp_f32 v83, v83
    v_mfma_f32_32x32x16_bf16 v[96:111], v[212:215], v[52:55], v[96:111]
    v_exp_f32 v84, v84
    v_exp_f32 v85, v85
    v_exp_f32 v86, v86
    v_exp_f32 v87, v87
    v_smfmac_f32_32x32x32_bf16 v[128:143], v[220:223], v[72:79], v22
    buffer_load_dwordx4 v[196:199], v26, s[20:23], s92 offen offset:1024 sc1
    v_exp_f32 v88, v88
    v_exp_f32 v89, v89
    v_exp_f32 v90, v90
    v_exp_f32 v91, v91
    v_smfmac_f32_32x32x32_bf16 v[144:159], v[216:219], v[80:87], v22
    v_exp_f32 v92, v92
    v_exp_f32 v93, v93
    v_exp_f32 v94, v94
    v_exp_f32 v95, v95
    v_mfma_f32_32x32x16_bf16 v[112:127], v[208:211], v[56:59], 0
    s_mov_b32 s93, 8192
    v_exp_f32 v96, v96
    v_exp_f32 v97, v97
    v_exp_f32 v98, v98
    v_exp_f32 v99, v99
    v_mfma_f32_32x32x16_bf16 v[112:127], v[212:215], v[60:63], v[112:127]
    v_exp_f32 v100, v100
    v_exp_f32 v101, v101
    v_exp_f32 v102, v102
    v_exp_f32 v103, v103
    v_smfmac_f32_32x32x32_bf16 v[144:159], v[220:223], v[88:95], v22
    buffer_load_dwordx4 v[200:203], v25, s[20:23], s93 offen offset:0 sc1
    v_exp_f32 v104, v104
    v_exp_f32 v105, v105
    v_exp_f32 v106, v106
    v_exp_f32 v107, v107
    v_smfmac_f32_32x32x32_bf16 v[160:175], v[216:219], v[96:103], v22
    s_waitcnt vmcnt(9)
    v_exp_f32 v108, v108
    v_exp_f32 v109, v109
    v_exp_f32 v110, v110
    v_exp_f32 v111, v111
    v_mfma_f32_32x32x16_bf16 v[64:79], v[224:227], v[32:35], 0
    v_exp_f32 v112, v112
    v_exp_f32 v113, v113
    v_exp_f32 v114, v114
    v_exp_f32 v115, v115
    v_mfma_f32_32x32x16_bf16 v[64:79], v[228:231], v[36:39], v[64:79]
    v_exp_f32 v116, v116
    v_exp_f32 v117, v117
    v_exp_f32 v118, v118
    v_exp_f32 v119, v119
    v_smfmac_f32_32x32x32_bf16 v[160:175], v[220:223], v[104:111], v22
    buffer_load_dwordx4 v[204:207], v25, s[20:23], s93 offen offset:1024 sc1
    v_exp_f32 v120, v120
    v_exp_f32 v121, v121
    v_exp_f32 v122, v122
    v_exp_f32 v123, v123
    v_smfmac_f32_32x32x32_bf16 v[176:191], v[216:219], v[112:119], v22
    s_waitcnt vmcnt(8)
    v_exp_f32 v124, v124
    v_exp_f32 v125, v125
    v_exp_f32 v126, v126
    v_exp_f32 v127, v127
    v_mfma_f32_32x32x16_bf16 v[80:95], v[224:227], v[40:43], 0
    s_mov_b32 s92, 430080
    v_exp_f32 v64, v64
    v_exp_f32 v65, v65
    v_exp_f32 v66, v66
    v_exp_f32 v67, v67
    v_mfma_f32_32x32x16_bf16 v[80:95], v[228:231], v[44:47], v[80:95]
    v_exp_f32 v68, v68
    v_exp_f32 v69, v69
    v_exp_f32 v70, v70
    v_exp_f32 v71, v71
    v_smfmac_f32_32x32x32_bf16 v[176:191], v[220:223], v[120:127], v22
    buffer_load_dwordx4 v[208:211], v26, s[20:23], s92 offen offset:0 sc1
    v_exp_f32 v72, v72
    v_exp_f32 v73, v73
    v_exp_f32 v74, v74
    v_exp_f32 v75, v75
    v_smfmac_f32_32x32x32_bf16 v[128:143], v[232:235], v[64:71], v22
    v_exp_f32 v76, v76
    v_exp_f32 v77, v77
    v_exp_f32 v78, v78
    v_exp_f32 v79, v79
    v_mfma_f32_32x32x16_bf16 v[96:111], v[224:227], v[48:51], 0
    v_exp_f32 v80, v80
    v_exp_f32 v81, v81
    v_exp_f32 v82, v82
    v_exp_f32 v83, v83
    v_mfma_f32_32x32x16_bf16 v[96:111], v[228:231], v[52:55], v[96:111]
    v_exp_f32 v84, v84
    v_exp_f32 v85, v85
    v_exp_f32 v86, v86
    v_exp_f32 v87, v87
    v_smfmac_f32_32x32x32_bf16 v[128:143], v[236:239], v[72:79], v22
    buffer_load_dwordx4 v[212:215], v26, s[20:23], s92 offen offset:1024 sc1
    v_exp_f32 v88, v88
    v_exp_f32 v89, v89
    v_exp_f32 v90, v90
    v_exp_f32 v91, v91
    v_smfmac_f32_32x32x32_bf16 v[144:159], v[232:235], v[80:87], v22
    v_exp_f32 v92, v92
    v_exp_f32 v93, v93
    v_exp_f32 v94, v94
    v_exp_f32 v95, v95
    v_mfma_f32_32x32x16_bf16 v[112:127], v[224:227], v[56:59], 0
    s_mov_b32 s93, 10240
    v_exp_f32 v96, v96
    v_exp_f32 v97, v97
    v_exp_f32 v98, v98
    v_exp_f32 v99, v99
    v_mfma_f32_32x32x16_bf16 v[112:127], v[228:231], v[60:63], v[112:127]
    v_exp_f32 v100, v100
    v_exp_f32 v101, v101
    v_exp_f32 v102, v102
    v_exp_f32 v103, v103
    v_smfmac_f32_32x32x32_bf16 v[144:159], v[236:239], v[88:95], v22
    buffer_load_dwordx4 v[216:219], v25, s[20:23], s93 offen offset:0 sc1
    v_exp_f32 v104, v104
    v_exp_f32 v105, v105
    v_exp_f32 v106, v106
    v_exp_f32 v107, v107
    v_smfmac_f32_32x32x32_bf16 v[160:175], v[232:235], v[96:103], v22
    s_waitcnt vmcnt(9)
    v_exp_f32 v108, v108
    v_exp_f32 v109, v109
    v_exp_f32 v110, v110
    v_exp_f32 v111, v111
    v_mfma_f32_32x32x16_bf16 v[64:79], v[240:243], v[32:35], 0
    v_exp_f32 v112, v112
    v_exp_f32 v113, v113
    v_exp_f32 v114, v114
    v_exp_f32 v115, v115
    v_mfma_f32_32x32x16_bf16 v[64:79], v[244:247], v[36:39], v[64:79]
    v_exp_f32 v116, v116
    v_exp_f32 v117, v117
    v_exp_f32 v118, v118
    v_exp_f32 v119, v119
    v_smfmac_f32_32x32x32_bf16 v[160:175], v[236:239], v[104:111], v22
    buffer_load_dwordx4 v[220:223], v25, s[20:23], s93 offen offset:1024 sc1
    v_exp_f32 v120, v120
    v_exp_f32 v121, v121
    v_exp_f32 v122, v122
    v_exp_f32 v123, v123
    v_smfmac_f32_32x32x32_bf16 v[176:191], v[232:235], v[112:119], v22
    s_waitcnt vmcnt(8)
    v_exp_f32 v124, v124
    v_exp_f32 v125, v125
    v_exp_f32 v126, v126
    v_exp_f32 v127, v127
    v_mfma_f32_32x32x16_bf16 v[80:95], v[240:243], v[40:43], 0
    s_mov_b32 s92, 516096
    v_exp_f32 v64, v64
    v_exp_f32 v65, v65
    v_exp_f32 v66, v66
    v_exp_f32 v67, v67
    v_mfma_f32_32x32x16_bf16 v[80:95], v[244:247], v[44:47], v[80:95]
    v_exp_f32 v68, v68
    v_exp_f32 v69, v69
    v_exp_f32 v70, v70
    v_exp_f32 v71, v71
    v_smfmac_f32_32x32x32_bf16 v[176:191], v[236:239], v[120:127], v22
    buffer_load_dwordx4 v[224:227], v26, s[20:23], s92 offen offset:0 sc1
    v_exp_f32 v72, v72
    v_exp_f32 v73, v73
    v_exp_f32 v74, v74
    v_exp_f32 v75, v75
    v_smfmac_f32_32x32x32_bf16 v[128:143], v[248:251], v[64:71], v22
    v_exp_f32 v76, v76
    v_exp_f32 v77, v77
    v_exp_f32 v78, v78
    v_exp_f32 v79, v79
    v_mfma_f32_32x32x16_bf16 v[96:111], v[240:243], v[48:51], 0
    v_exp_f32 v80, v80
    v_exp_f32 v81, v81
    v_exp_f32 v82, v82
    v_exp_f32 v83, v83
    v_mfma_f32_32x32x16_bf16 v[96:111], v[244:247], v[52:55], v[96:111]
    v_exp_f32 v84, v84
    v_exp_f32 v85, v85
    v_exp_f32 v86, v86
    v_exp_f32 v87, v87
    v_smfmac_f32_32x32x32_bf16 v[128:143], v[252:255], v[72:79], v22
    buffer_load_dwordx4 v[228:231], v26, s[20:23], s92 offen offset:1024 sc1
    v_exp_f32 v88, v88
    v_exp_f32 v89, v89
    v_exp_f32 v90, v90
    v_exp_f32 v91, v91
    v_smfmac_f32_32x32x32_bf16 v[144:159], v[248:251], v[80:87], v22
    v_exp_f32 v92, v92
    v_exp_f32 v93, v93
    v_exp_f32 v94, v94
    v_exp_f32 v95, v95
    v_mfma_f32_32x32x16_bf16 v[112:127], v[240:243], v[56:59], 0
    s_mov_b32 s93, 12288
    v_exp_f32 v96, v96
    v_exp_f32 v97, v97
    v_exp_f32 v98, v98
    v_exp_f32 v99, v99
    v_mfma_f32_32x32x16_bf16 v[112:127], v[244:247], v[60:63], v[112:127]
    v_exp_f32 v100, v100
    v_exp_f32 v101, v101
    v_exp_f32 v102, v102
    v_exp_f32 v103, v103
    v_smfmac_f32_32x32x32_bf16 v[144:159], v[252:255], v[88:95], v22
    buffer_load_dwordx4 v[232:235], v25, s[20:23], s93 offen offset:0 sc1
    v_exp_f32 v104, v104
    v_exp_f32 v105, v105
    v_exp_f32 v106, v106
    v_exp_f32 v107, v107
    v_smfmac_f32_32x32x32_bf16 v[160:175], v[248:251], v[96:103], v22
    s_waitcnt vmcnt(9)
    v_exp_f32 v108, v108
    v_exp_f32 v109, v109
    v_exp_f32 v110, v110
    v_exp_f32 v111, v111
    v_mfma_f32_32x32x16_bf16 v[64:79], v[192:195], v[32:35], 0
    v_exp_f32 v112, v112
    v_exp_f32 v113, v113
    v_exp_f32 v114, v114
    v_exp_f32 v115, v115
    v_mfma_f32_32x32x16_bf16 v[64:79], v[196:199], v[36:39], v[64:79]
    v_exp_f32 v116, v116
    v_exp_f32 v117, v117
    v_exp_f32 v118, v118
    v_exp_f32 v119, v119
    v_smfmac_f32_32x32x32_bf16 v[160:175], v[252:255], v[104:111], v22
    buffer_load_dwordx4 v[236:239], v25, s[20:23], s93 offen offset:1024 sc1
    v_exp_f32 v120, v120
    v_exp_f32 v121, v121
    v_exp_f32 v122, v122
    v_exp_f32 v123, v123
    v_smfmac_f32_32x32x32_bf16 v[176:191], v[248:251], v[112:119], v22
    s_waitcnt vmcnt(8)
    v_exp_f32 v124, v124
    v_exp_f32 v125, v125
    v_exp_f32 v126, v126
    v_exp_f32 v127, v127
    v_mfma_f32_32x32x16_bf16 v[80:95], v[192:195], v[40:43], 0
    s_mov_b32 s92, 602112
    v_exp_f32 v64, v64
    v_exp_f32 v65, v65
    v_exp_f32 v66, v66
    v_exp_f32 v67, v67
    v_mfma_f32_32x32x16_bf16 v[80:95], v[196:199], v[44:47], v[80:95]
    v_exp_f32 v68, v68
    v_exp_f32 v69, v69
    v_exp_f32 v70, v70
    v_exp_f32 v71, v71
    v_smfmac_f32_32x32x32_bf16 v[176:191], v[252:255], v[120:127], v22
    buffer_load_dwordx4 v[240:243], v26, s[20:23], s92 offen offset:0 sc1
    v_exp_f32 v72, v72
    v_exp_f32 v73, v73
    v_exp_f32 v74, v74
    v_exp_f32 v75, v75
    v_smfmac_f32_32x32x32_bf16 v[128:143], v[200:203], v[64:71], v22
    v_exp_f32 v76, v76
    v_exp_f32 v77, v77
    v_exp_f32 v78, v78
    v_exp_f32 v79, v79
    v_mfma_f32_32x32x16_bf16 v[96:111], v[192:195], v[48:51], 0
    v_exp_f32 v80, v80
    v_exp_f32 v81, v81
    v_exp_f32 v82, v82
    v_exp_f32 v83, v83
    v_mfma_f32_32x32x16_bf16 v[96:111], v[196:199], v[52:55], v[96:111]
    v_exp_f32 v84, v84
    v_exp_f32 v85, v85
    v_exp_f32 v86, v86
    v_exp_f32 v87, v87
    v_smfmac_f32_32x32x32_bf16 v[128:143], v[204:207], v[72:79], v22
    buffer_load_dwordx4 v[244:247], v26, s[20:23], s92 offen offset:1024 sc1
    v_exp_f32 v88, v88
    v_exp_f32 v89, v89
    v_exp_f32 v90, v90
    v_exp_f32 v91, v91
    v_smfmac_f32_32x32x32_bf16 v[144:159], v[200:203], v[80:87], v22
    v_exp_f32 v92, v92
    v_exp_f32 v93, v93
    v_exp_f32 v94, v94
    v_exp_f32 v95, v95
    v_mfma_f32_32x32x16_bf16 v[112:127], v[192:195], v[56:59], 0
    s_mov_b32 s93, 14336
    v_exp_f32 v96, v96
    v_exp_f32 v97, v97
    v_exp_f32 v98, v98
    v_exp_f32 v99, v99
    v_mfma_f32_32x32x16_bf16 v[112:127], v[196:199], v[60:63], v[112:127]
    v_exp_f32 v100, v100
    v_exp_f32 v101, v101
    v_exp_f32 v102, v102
    v_exp_f32 v103, v103
    v_smfmac_f32_32x32x32_bf16 v[144:159], v[204:207], v[88:95], v22
    buffer_load_dwordx4 v[248:251], v25, s[20:23], s93 offen offset:0 sc1
    v_exp_f32 v104, v104
    v_exp_f32 v105, v105
    v_exp_f32 v106, v106
    v_exp_f32 v107, v107
    v_smfmac_f32_32x32x32_bf16 v[160:175], v[200:203], v[96:103], v22
    s_waitcnt vmcnt(9)
    v_exp_f32 v108, v108
    v_exp_f32 v109, v109
    v_exp_f32 v110, v110
    v_exp_f32 v111, v111
    v_mfma_f32_32x32x16_bf16 v[64:79], v[208:211], v[32:35], 0
    v_exp_f32 v112, v112
    v_exp_f32 v113, v113
    v_exp_f32 v114, v114
    v_exp_f32 v115, v115
    v_mfma_f32_32x32x16_bf16 v[64:79], v[212:215], v[36:39], v[64:79]
    v_exp_f32 v116, v116
    v_exp_f32 v117, v117
    v_exp_f32 v118, v118
    v_exp_f32 v119, v119
    v_smfmac_f32_32x32x32_bf16 v[160:175], v[204:207], v[104:111], v22
    buffer_load_dwordx4 v[252:255], v25, s[20:23], s93 offen offset:1024 sc1
    v_exp_f32 v120, v120
    v_exp_f32 v121, v121
    v_exp_f32 v122, v122
    v_exp_f32 v123, v123
    v_smfmac_f32_32x32x32_bf16 v[176:191], v[200:203], v[112:119], v22
    s_waitcnt vmcnt(8)
    v_exp_f32 v124, v124
    v_exp_f32 v125, v125
    v_exp_f32 v126, v126
    v_exp_f32 v127, v127
    v_mfma_f32_32x32x16_bf16 v[80:95], v[208:211], v[40:43], 0
    s_mov_b32 s92, 688128
    v_exp_f32 v64, v64
    v_exp_f32 v65, v65
    v_exp_f32 v66, v66
    v_exp_f32 v67, v67
    v_mfma_f32_32x32x16_bf16 v[80:95], v[212:215], v[44:47], v[80:95]
    v_exp_f32 v68, v68
    v_exp_f32 v69, v69
    v_exp_f32 v70, v70
    v_exp_f32 v71, v71
    v_smfmac_f32_32x32x32_bf16 v[176:191], v[204:207], v[120:127], v22
    buffer_load_dwordx4 v[192:195], v26, s[20:23], s92 offen offset:0 sc1
    v_exp_f32 v72, v72
    v_exp_f32 v73, v73
    v_exp_f32 v74, v74
    v_exp_f32 v75, v75
    v_smfmac_f32_32x32x32_bf16 v[128:143], v[216:219], v[64:71], v22
    v_exp_f32 v76, v76
    v_exp_f32 v77, v77
    v_exp_f32 v78, v78
    v_exp_f32 v79, v79
    v_mfma_f32_32x32x16_bf16 v[96:111], v[208:211], v[48:51], 0
    v_exp_f32 v80, v80
    v_exp_f32 v81, v81
    v_exp_f32 v82, v82
    v_exp_f32 v83, v83
    v_mfma_f32_32x32x16_bf16 v[96:111], v[212:215], v[52:55], v[96:111]
    v_exp_f32 v84, v84
    v_exp_f32 v85, v85
    v_exp_f32 v86, v86
    v_exp_f32 v87, v87
    v_smfmac_f32_32x32x32_bf16 v[128:143], v[220:223], v[72:79], v22
    buffer_load_dwordx4 v[196:199], v26, s[20:23], s92 offen offset:1024 sc1
    v_exp_f32 v88, v88
    v_exp_f32 v89, v89
    v_exp_f32 v90, v90
    v_exp_f32 v91, v91
    v_smfmac_f32_32x32x32_bf16 v[144:159], v[216:219], v[80:87], v22
    v_exp_f32 v92, v92
    v_exp_f32 v93, v93
    v_exp_f32 v94, v94
    v_exp_f32 v95, v95
    v_mfma_f32_32x32x16_bf16 v[112:127], v[208:211], v[56:59], 0
    s_mov_b32 s93, 16384
    v_exp_f32 v96, v96
    v_exp_f32 v97, v97
    v_exp_f32 v98, v98
    v_exp_f32 v99, v99
    v_mfma_f32_32x32x16_bf16 v[112:127], v[212:215], v[60:63], v[112:127]
    v_exp_f32 v100, v100
    v_exp_f32 v101, v101
    v_exp_f32 v102, v102
    v_exp_f32 v103, v103
    v_smfmac_f32_32x32x32_bf16 v[144:159], v[220:223], v[88:95], v22
    buffer_load_dwordx4 v[200:203], v25, s[20:23], s93 offen offset:0 sc1
    v_exp_f32 v104, v104
    v_exp_f32 v105, v105
    v_exp_f32 v106, v106
    v_exp_f32 v107, v107
    v_smfmac_f32_32x32x32_bf16 v[160:175], v[216:219], v[96:103], v22
    s_waitcnt vmcnt(9)
    v_exp_f32 v108, v108
    v_exp_f32 v109, v109
    v_exp_f32 v110, v110
    v_exp_f32 v111, v111
    v_mfma_f32_32x32x16_bf16 v[64:79], v[224:227], v[32:35], 0
    v_exp_f32 v112, v112
    v_exp_f32 v113, v113
    v_exp_f32 v114, v114
    v_exp_f32 v115, v115
    v_mfma_f32_32x32x16_bf16 v[64:79], v[228:231], v[36:39], v[64:79]
    v_exp_f32 v116, v116
    v_exp_f32 v117, v117
    v_exp_f32 v118, v118
    v_exp_f32 v119, v119
    v_smfmac_f32_32x32x32_bf16 v[160:175], v[220:223], v[104:111], v22
    buffer_load_dwordx4 v[204:207], v25, s[20:23], s93 offen offset:1024 sc1
    v_exp_f32 v120, v120
    v_exp_f32 v121, v121
    v_exp_f32 v122, v122
    v_exp_f32 v123, v123
    v_smfmac_f32_32x32x32_bf16 v[176:191], v[216:219], v[112:119], v22
    s_waitcnt vmcnt(8)
    v_exp_f32 v124, v124
    v_exp_f32 v125, v125
    v_exp_f32 v126, v126
    v_exp_f32 v127, v127
    v_mfma_f32_32x32x16_bf16 v[80:95], v[224:227], v[40:43], 0
    s_mov_b32 s92, 774144
    v_exp_f32 v64, v64
    v_exp_f32 v65, v65
    v_exp_f32 v66, v66
    v_exp_f32 v67, v67
    v_mfma_f32_32x32x16_bf16 v[80:95], v[228:231], v[44:47], v[80:95]
    v_exp_f32 v68, v68
    v_exp_f32 v69, v69
    v_exp_f32 v70, v70
    v_exp_f32 v71, v71
    v_smfmac_f32_32x32x32_bf16 v[176:191], v[220:223], v[120:127], v22
    buffer_load_dwordx4 v[208:211], v26, s[20:23], s92 offen offset:0 sc1
    v_exp_f32 v72, v72
    v_exp_f32 v73, v73
    v_exp_f32 v74, v74
    v_exp_f32 v75, v75
    v_smfmac_f32_32x32x32_bf16 v[128:143], v[232:235], v[64:71], v22
    v_exp_f32 v76, v76
    v_exp_f32 v77, v77
    v_exp_f32 v78, v78
    v_exp_f32 v79, v79
    v_mfma_f32_32x32x16_bf16 v[96:111], v[224:227], v[48:51], 0
    v_exp_f32 v80, v80
    v_exp_f32 v81, v81
    v_exp_f32 v82, v82
    v_exp_f32 v83, v83
    v_mfma_f32_32x32x16_bf16 v[96:111], v[228:231], v[52:55], v[96:111]
    v_exp_f32 v84, v84
    v_exp_f32 v85, v85
    v_exp_f32 v86, v86
    v_exp_f32 v87, v87
    v_smfmac_f32_32x32x32_bf16 v[128:143], v[236:239], v[72:79], v22
    buffer_load_dwordx4 v[212:215], v26, s[20:23], s92 offen offset:1024 sc1
    v_exp_f32 v88, v88
    v_exp_f32 v89, v89
    v_exp_f32 v90, v90
    v_exp_f32 v91, v91
    v_smfmac_f32_32x32x32_bf16 v[144:159], v[232:235], v[80:87], v22
    v_exp_f32 v92, v92
    v_exp_f32 v93, v93
    v_exp_f32 v94, v94
    v_exp_f32 v95, v95
    v_mfma_f32_32x32x16_bf16 v[112:127], v[224:227], v[56:59], 0
    s_mov_b32 s93, 18432
    v_exp_f32 v96, v96
    v_exp_f32 v97, v97
    v_exp_f32 v98, v98
    v_exp_f32 v99, v99
    v_mfma_f32_32x32x16_bf16 v[112:127], v[228:231], v[60:63], v[112:127]
    v_exp_f32 v100, v100
    v_exp_f32 v101, v101
    v_exp_f32 v102, v102
    v_exp_f32 v103, v103
    v_smfmac_f32_32x32x32_bf16 v[144:159], v[236:239], v[88:95], v22
    buffer_load_dwordx4 v[216:219], v25, s[20:23], s93 offen offset:0 sc1
    v_exp_f32 v104, v104
    v_exp_f32 v105, v105
    v_exp_f32 v106, v106
    v_exp_f32 v107, v107
    v_smfmac_f32_32x32x32_bf16 v[160:175], v[232:235], v[96:103], v22
    s_waitcnt vmcnt(9)
    v_exp_f32 v108, v108
    v_exp_f32 v109, v109
    v_exp_f32 v110, v110
    v_exp_f32 v111, v111
    v_mfma_f32_32x32x16_bf16 v[64:79], v[240:243], v[32:35], 0
    v_exp_f32 v112, v112
    v_exp_f32 v113, v113
    v_exp_f32 v114, v114
    v_exp_f32 v115, v115
    v_mfma_f32_32x32x16_bf16 v[64:79], v[244:247], v[36:39], v[64:79]
    v_exp_f32 v116, v116
    v_exp_f32 v117, v117
    v_exp_f32 v118, v118
    v_exp_f32 v119, v119
    v_smfmac_f32_32x32x32_bf16 v[160:175], v[236:239], v[104:111], v22
    buffer_load_dwordx4 v[220:223], v25, s[20:23], s93 offen offset:1024 sc1
    v_exp_f32 v120, v120
    v_exp_f32 v121, v121
    v_exp_f32 v122, v122
    v_exp_f32 v123, v123
    v_smfmac_f32_32x32x32_bf16 v[176:191], v[232:235], v[112:119], v22
    s_waitcnt vmcnt(8)
    v_exp_f32 v124, v124
    v_exp_f32 v125, v125
    v_exp_f32 v126, v126
    v_exp_f32 v127, v127
    v_mfma_f32_32x32x16_bf16 v[80:95], v[240:243], v[40:43], 0
    s_mov_b32 s92, 860160
    v_exp_f32 v64, v64
    v_exp_f32 v65, v65
    v_exp_f32 v66, v66
    v_exp_f32 v67, v67
    v_mfma_f32_32x32x16_bf16 v[80:95], v[244:247], v[44:47], v[80:95]
    v_exp_f32 v68, v68
    v_exp_f32 v69, v69
    v_exp_f32 v70, v70
    v_exp_f32 v71, v71
    v_smfmac_f32_32x32x32_bf16 v[176:191], v[236:239], v[120:127], v22
    buffer_load_dwordx4 v[224:227], v26, s[20:23], s92 offen offset:0 sc1
    v_exp_f32 v72, v72
    v_exp_f32 v73, v73
    v_exp_f32 v74, v74
    v_exp_f32 v75, v75
    v_smfmac_f32_32x32x32_bf16 v[128:143], v[248:251], v[64:71], v22
    v_exp_f32 v76, v76
    v_exp_f32 v77, v77
    v_exp_f32 v78, v78
    v_exp_f32 v79, v79
    v_mfma_f32_32x32x16_bf16 v[96:111], v[240:243], v[48:51], 0
    v_exp_f32 v80, v80
    v_exp_f32 v81, v81
    v_exp_f32 v82, v82
    v_exp_f32 v83, v83
    v_mfma_f32_32x32x16_bf16 v[96:111], v[244:247], v[52:55], v[96:111]
    v_exp_f32 v84, v84
    v_exp_f32 v85, v85
    v_exp_f32 v86, v86
    v_exp_f32 v87, v87
    v_smfmac_f32_32x32x32_bf16 v[128:143], v[252:255], v[72:79], v22
    buffer_load_dwordx4 v[228:231], v26, s[20:23], s92 offen offset:1024 sc1
    v_exp_f32 v88, v88
    v_exp_f32 v89, v89
    v_exp_f32 v90, v90
    v_exp_f32 v91, v91
    v_smfmac_f32_32x32x32_bf16 v[144:159], v[248:251], v[80:87], v22
    v_exp_f32 v92, v92
    v_exp_f32 v93, v93
    v_exp_f32 v94, v94
    v_exp_f32 v95, v95
    v_mfma_f32_32x32x16_bf16 v[112:127], v[240:243], v[56:59], 0
    s_mov_b32 s93, 20480
    v_exp_f32 v96, v96
    v_exp_f32 v97, v97
    v_exp_f32 v98, v98
    v_exp_f32 v99, v99
    v_mfma_f32_32x32x16_bf16 v[112:127], v[244:247], v[60:63], v[112:127]
    v_exp_f32 v100, v100
    v_exp_f32 v101, v101
    v_exp_f32 v102, v102
    v_exp_f32 v103, v103
    v_smfmac_f32_32x32x32_bf16 v[144:159], v[252:255], v[88:95], v22
    buffer_load_dwordx4 v[232:235], v25, s[20:23], s93 offen offset:0 sc1
    v_exp_f32 v104, v104
    v_exp_f32 v105, v105
    v_exp_f32 v106, v106
    v_exp_f32 v107, v107
    v_smfmac_f32_32x32x32_bf16 v[160:175], v[248:251], v[96:103], v22
    s_waitcnt vmcnt(9)
    v_exp_f32 v108, v108
    v_exp_f32 v109, v109
    v_exp_f32 v110, v110
    v_exp_f32 v111, v111
    v_mfma_f32_32x32x16_bf16 v[64:79], v[192:195], v[32:35], 0
    v_exp_f32 v112, v112
    v_exp_f32 v113, v113
    v_exp_f32 v114, v114
    v_exp_f32 v115, v115
    v_mfma_f32_32x32x16_bf16 v[64:79], v[196:199], v[36:39], v[64:79]
    v_exp_f32 v116, v116
    v_exp_f32 v117, v117
    v_exp_f32 v118, v118
    v_exp_f32 v119, v119
    v_smfmac_f32_32x32x32_bf16 v[160:175], v[252:255], v[104:111], v22
    buffer_load_dwordx4 v[236:239], v25, s[20:23], s93 offen offset:1024 sc1
    v_exp_f32 v120, v120
    v_exp_f32 v121, v121
    v_exp_f32 v122, v122
    v_exp_f32 v123, v123
    v_smfmac_f32_32x32x32_bf16 v[176:191], v[248:251], v[112:119], v22
    s_waitcnt vmcnt(8)
    v_exp_f32 v124, v124
    v_exp_f32 v125, v125
    v_exp_f32 v126, v126
    v_exp_f32 v127, v127
    v_mfma_f32_32x32x16_bf16 v[80:95], v[192:195], v[40:43], 0
    s_mov_b32 s92, 946176
    v_exp_f32 v64, v64
    v_exp_f32 v65, v65
    v_exp_f32 v66, v66
    v_exp_f32 v67, v67
    v_mfma_f32_32x32x16_bf16 v[80:95], v[196:199], v[44:47], v[80:95]
    v_exp_f32 v68, v68
    v_exp_f32 v69, v69
    v_exp_f32 v70, v70
    v_exp_f32 v71, v71
    v_smfmac_f32_32x32x32_bf16 v[176:191], v[252:255], v[120:127], v22
    buffer_load_dwordx4 v[240:243], v26, s[20:23], s92 offen offset:0 sc1
    v_exp_f32 v72, v72
    v_exp_f32 v73, v73
    v_exp_f32 v74, v74
    v_exp_f32 v75, v75
    v_smfmac_f32_32x32x32_bf16 v[128:143], v[200:203], v[64:71], v22
    v_exp_f32 v76, v76
    v_exp_f32 v77, v77
    v_exp_f32 v78, v78
    v_exp_f32 v79, v79
    v_mfma_f32_32x32x16_bf16 v[96:111], v[192:195], v[48:51], 0
    v_exp_f32 v80, v80
    v_exp_f32 v81, v81
    v_exp_f32 v82, v82
    v_exp_f32 v83, v83
    v_mfma_f32_32x32x16_bf16 v[96:111], v[196:199], v[52:55], v[96:111]
    v_exp_f32 v84, v84
    v_exp_f32 v85, v85
    v_exp_f32 v86, v86
    v_exp_f32 v87, v87
    v_smfmac_f32_32x32x32_bf16 v[128:143], v[204:207], v[72:79], v22
    buffer_load_dwordx4 v[244:247], v26, s[20:23], s92 offen offset:1024 sc1
    v_exp_f32 v88, v88
    v_exp_f32 v89, v89
    v_exp_f32 v90, v90
    v_exp_f32 v91, v91
    v_smfmac_f32_32x32x32_bf16 v[144:159], v[200:203], v[80:87], v22
    v_exp_f32 v92, v92
    v_exp_f32 v93, v93
    v_exp_f32 v94, v94
    v_exp_f32 v95, v95
    v_mfma_f32_32x32x16_bf16 v[112:127], v[192:195], v[56:59], 0
    s_mov_b32 s93, 22528
    v_exp_f32 v96, v96
    v_exp_f32 v97, v97
    v_exp_f32 v98, v98
    v_exp_f32 v99, v99
    v_mfma_f32_32x32x16_bf16 v[112:127], v[196:199], v[60:63], v[112:127]
    v_exp_f32 v100, v100
    v_exp_f32 v101, v101
    v_exp_f32 v102, v102
    v_exp_f32 v103, v103
    v_smfmac_f32_32x32x32_bf16 v[144:159], v[204:207], v[88:95], v22
    buffer_load_dwordx4 v[248:251], v25, s[20:23], s93 offen offset:0 sc1
    v_exp_f32 v104, v104
    v_exp_f32 v105, v105
    v_exp_f32 v106, v106
    v_exp_f32 v107, v107
    v_smfmac_f32_32x32x32_bf16 v[160:175], v[200:203], v[96:103], v22
    s_waitcnt vmcnt(9)
    v_exp_f32 v108, v108
    v_exp_f32 v109, v109
    v_exp_f32 v110, v110
    v_exp_f32 v111, v111
    v_mfma_f32_32x32x16_bf16 v[64:79], v[208:211], v[32:35], 0
    v_exp_f32 v112, v112
    v_exp_f32 v113, v113
    v_exp_f32 v114, v114
    v_exp_f32 v115, v115
    v_mfma_f32_32x32x16_bf16 v[64:79], v[212:215], v[36:39], v[64:79]
    v_exp_f32 v116, v116
    v_exp_f32 v117, v117
    v_exp_f32 v118, v118
    v_exp_f32 v119, v119
    v_smfmac_f32_32x32x32_bf16 v[160:175], v[204:207], v[104:111], v22
    buffer_load_dwordx4 v[252:255], v25, s[20:23], s93 offen offset:1024 sc1
    v_exp_f32 v120, v120
    v_exp_f32 v121, v121
    v_exp_f32 v122, v122
    v_exp_f32 v123, v123
    v_smfmac_f32_32x32x32_bf16 v[176:191], v[200:203], v[112:119], v22
    s_waitcnt vmcnt(8)
    v_exp_f32 v124, v124
    v_exp_f32 v125, v125
    v_exp_f32 v126, v126
    v_exp_f32 v127, v127
    v_mfma_f32_32x32x16_bf16 v[80:95], v[208:211], v[40:43], 0
    s_mov_b32 s92, 1032192
    v_exp_f32 v64, v64
    v_exp_f32 v65, v65
    v_exp_f32 v66, v66
    v_exp_f32 v67, v67
    v_mfma_f32_32x32x16_bf16 v[80:95], v[212:215], v[44:47], v[80:95]
    v_exp_f32 v68, v68
    v_exp_f32 v69, v69
    v_exp_f32 v70, v70
    v_exp_f32 v71, v71
    v_smfmac_f32_32x32x32_bf16 v[176:191], v[204:207], v[120:127], v22
    buffer_load_dwordx4 v[192:195], v26, s[20:23], s92 offen offset:0 sc1
    v_exp_f32 v72, v72
    v_exp_f32 v73, v73
    v_exp_f32 v74, v74
    v_exp_f32 v75, v75
    v_smfmac_f32_32x32x32_bf16 v[128:143], v[216:219], v[64:71], v22
    v_exp_f32 v76, v76
    v_exp_f32 v77, v77
    v_exp_f32 v78, v78
    v_exp_f32 v79, v79
    v_mfma_f32_32x32x16_bf16 v[96:111], v[208:211], v[48:51], 0
    v_exp_f32 v80, v80
    v_exp_f32 v81, v81
    v_exp_f32 v82, v82
    v_exp_f32 v83, v83
    v_mfma_f32_32x32x16_bf16 v[96:111], v[212:215], v[52:55], v[96:111]
    v_exp_f32 v84, v84
    v_exp_f32 v85, v85
    v_exp_f32 v86, v86
    v_exp_f32 v87, v87
    v_smfmac_f32_32x32x32_bf16 v[128:143], v[220:223], v[72:79], v22
    buffer_load_dwordx4 v[196:199], v26, s[20:23], s92 offen offset:1024 sc1
    v_exp_f32 v88, v88
    v_exp_f32 v89, v89
    v_exp_f32 v90, v90
    v_exp_f32 v91, v91
    v_smfmac_f32_32x32x32_bf16 v[144:159], v[216:219], v[80:87], v22
    v_exp_f32 v92, v92
    v_exp_f32 v93, v93
    v_exp_f32 v94, v94
    v_exp_f32 v95, v95
    v_mfma_f32_32x32x16_bf16 v[112:127], v[208:211], v[56:59], 0
    s_mov_b32 s93, 24576
    v_exp_f32 v96, v96
    v_exp_f32 v97, v97
    v_exp_f32 v98, v98
    v_exp_f32 v99, v99
    v_mfma_f32_32x32x16_bf16 v[112:127], v[212:215], v[60:63], v[112:127]
    v_exp_f32 v100, v100
    v_exp_f32 v101, v101
    v_exp_f32 v102, v102
    v_exp_f32 v103, v103
    v_smfmac_f32_32x32x32_bf16 v[144:159], v[220:223], v[88:95], v22
    buffer_load_dwordx4 v[200:203], v25, s[20:23], s93 offen offset:0 sc1
    v_exp_f32 v104, v104
    v_exp_f32 v105, v105
    v_exp_f32 v106, v106
    v_exp_f32 v107, v107
    v_smfmac_f32_32x32x32_bf16 v[160:175], v[216:219], v[96:103], v22
    s_waitcnt vmcnt(9)
    v_exp_f32 v108, v108
    v_exp_f32 v109, v109
    v_exp_f32 v110, v110
    v_exp_f32 v111, v111
    v_mfma_f32_32x32x16_bf16 v[64:79], v[224:227], v[32:35], 0
    v_exp_f32 v112, v112
    v_exp_f32 v113, v113
    v_exp_f32 v114, v114
    v_exp_f32 v115, v115
    v_mfma_f32_32x32x16_bf16 v[64:79], v[228:231], v[36:39], v[64:79]
    v_exp_f32 v116, v116
    v_exp_f32 v117, v117
    v_exp_f32 v118, v118
    v_exp_f32 v119, v119
    v_smfmac_f32_32x32x32_bf16 v[160:175], v[220:223], v[104:111], v22
    buffer_load_dwordx4 v[204:207], v25, s[20:23], s93 offen offset:1024 sc1
    v_exp_f32 v120, v120
    v_exp_f32 v121, v121
    v_exp_f32 v122, v122
    v_exp_f32 v123, v123
    v_smfmac_f32_32x32x32_bf16 v[176:191], v[216:219], v[112:119], v22
    s_waitcnt vmcnt(8)
    v_exp_f32 v124, v124
    v_exp_f32 v125, v125
    v_exp_f32 v126, v126
    v_exp_f32 v127, v127
    v_mfma_f32_32x32x16_bf16 v[80:95], v[224:227], v[40:43], 0
    s_mov_b32 s92, 1118208
    v_exp_f32 v64, v64
    v_exp_f32 v65, v65
    v_exp_f32 v66, v66
    v_exp_f32 v67, v67
    v_mfma_f32_32x32x16_bf16 v[80:95], v[228:231], v[44:47], v[80:95]
    v_exp_f32 v68, v68
    v_exp_f32 v69, v69
    v_exp_f32 v70, v70
    v_exp_f32 v71, v71
    v_smfmac_f32_32x32x32_bf16 v[176:191], v[220:223], v[120:127], v22
    buffer_load_dwordx4 v[208:211], v26, s[20:23], s92 offen offset:0 sc1
    v_exp_f32 v72, v72
    v_exp_f32 v73, v73
    v_exp_f32 v74, v74
    v_exp_f32 v75, v75
    v_smfmac_f32_32x32x32_bf16 v[128:143], v[232:235], v[64:71], v22
    v_exp_f32 v76, v76
    v_exp_f32 v77, v77
    v_exp_f32 v78, v78
    v_exp_f32 v79, v79
    v_mfma_f32_32x32x16_bf16 v[96:111], v[224:227], v[48:51], 0
    v_exp_f32 v80, v80
    v_exp_f32 v81, v81
    v_exp_f32 v82, v82
    v_exp_f32 v83, v83
    v_mfma_f32_32x32x16_bf16 v[96:111], v[228:231], v[52:55], v[96:111]
    v_exp_f32 v84, v84
    v_exp_f32 v85, v85
    v_exp_f32 v86, v86
    v_exp_f32 v87, v87
    v_smfmac_f32_32x32x32_bf16 v[128:143], v[236:239], v[72:79], v22
    buffer_load_dwordx4 v[212:215], v26, s[20:23], s92 offen offset:1024 sc1
    v_exp_f32 v88, v88
    v_exp_f32 v89, v89
    v_exp_f32 v90, v90
    v_exp_f32 v91, v91
    v_smfmac_f32_32x32x32_bf16 v[144:159], v[232:235], v[80:87], v22
    v_exp_f32 v92, v92
    v_exp_f32 v93, v93
    v_exp_f32 v94, v94
    v_exp_f32 v95, v95
    v_mfma_f32_32x32x16_bf16 v[112:127], v[224:227], v[56:59], 0
    s_mov_b32 s93, 26624
    v_exp_f32 v96, v96
    v_exp_f32 v97, v97
    v_exp_f32 v98, v98
    v_exp_f32 v99, v99
    v_mfma_f32_32x32x16_bf16 v[112:127], v[228:231], v[60:63], v[112:127]
    v_exp_f32 v100, v100
    v_exp_f32 v101, v101
    v_exp_f32 v102, v102
    v_exp_f32 v103, v103
    v_smfmac_f32_32x32x32_bf16 v[144:159], v[236:239], v[88:95], v22
    buffer_load_dwordx4 v[216:219], v25, s[20:23], s93 offen offset:0 sc1
    v_exp_f32 v104, v104
    v_exp_f32 v105, v105
    v_exp_f32 v106, v106
    v_exp_f32 v107, v107
    v_smfmac_f32_32x32x32_bf16 v[160:175], v[232:235], v[96:103], v22
    s_waitcnt vmcnt(9)
    v_exp_f32 v108, v108
    v_exp_f32 v109, v109
    v_exp_f32 v110, v110
    v_exp_f32 v111, v111
    v_mfma_f32_32x32x16_bf16 v[64:79], v[240:243], v[32:35], 0
    v_exp_f32 v112, v112
    v_exp_f32 v113, v113
    v_exp_f32 v114, v114
    v_exp_f32 v115, v115
    v_mfma_f32_32x32x16_bf16 v[64:79], v[244:247], v[36:39], v[64:79]
    v_exp_f32 v116, v116
    v_exp_f32 v117, v117
    v_exp_f32 v118, v118
    v_exp_f32 v119, v119
    v_smfmac_f32_32x32x32_bf16 v[160:175], v[236:239], v[104:111], v22
    buffer_load_dwordx4 v[220:223], v25, s[20:23], s93 offen offset:1024 sc1
    v_exp_f32 v120, v120
    v_exp_f32 v121, v121
    v_exp_f32 v122, v122
    v_exp_f32 v123, v123
    v_smfmac_f32_32x32x32_bf16 v[176:191], v[232:235], v[112:119], v22
    s_waitcnt vmcnt(8)
    v_exp_f32 v124, v124
    v_exp_f32 v125, v125
    v_exp_f32 v126, v126
    v_exp_f32 v127, v127
    v_mfma_f32_32x32x16_bf16 v[80:95], v[240:243], v[40:43], 0
    s_mov_b32 s92, 1204224
    v_exp_f32 v64, v64
    v_exp_f32 v65, v65
    v_exp_f32 v66, v66
    v_exp_f32 v67, v67
    v_mfma_f32_32x32x16_bf16 v[80:95], v[244:247], v[44:47], v[80:95]
    v_exp_f32 v68, v68
    v_exp_f32 v69, v69
    v_exp_f32 v70, v70
    v_exp_f32 v71, v71
    v_smfmac_f32_32x32x32_bf16 v[176:191], v[236:239], v[120:127], v22
    buffer_load_dwordx4 v[224:227], v26, s[20:23], s92 offen offset:0 sc1
    v_exp_f32 v72, v72
    v_exp_f32 v73, v73
    v_exp_f32 v74, v74
    v_exp_f32 v75, v75
    v_smfmac_f32_32x32x32_bf16 v[128:143], v[248:251], v[64:71], v22
    v_exp_f32 v76, v76
    v_exp_f32 v77, v77
    v_exp_f32 v78, v78
    v_exp_f32 v79, v79
    v_mfma_f32_32x32x16_bf16 v[96:111], v[240:243], v[48:51], 0
    v_exp_f32 v80, v80
    v_exp_f32 v81, v81
    v_exp_f32 v82, v82
    v_exp_f32 v83, v83
    v_mfma_f32_32x32x16_bf16 v[96:111], v[244:247], v[52:55], v[96:111]
    v_exp_f32 v84, v84
    v_exp_f32 v85, v85
    v_exp_f32 v86, v86
    v_exp_f32 v87, v87
    v_smfmac_f32_32x32x32_bf16 v[128:143], v[252:255], v[72:79], v22
    buffer_load_dwordx4 v[228:231], v26, s[20:23], s92 offen offset:1024 sc1
    v_exp_f32 v88, v88
    v_exp_f32 v89, v89
    v_exp_f32 v90, v90
    v_exp_f32 v91, v91
    v_smfmac_f32_32x32x32_bf16 v[144:159], v[248:251], v[80:87], v22
    v_exp_f32 v92, v92
    v_exp_f32 v93, v93
    v_exp_f32 v94, v94
    v_exp_f32 v95, v95
    v_mfma_f32_32x32x16_bf16 v[112:127], v[240:243], v[56:59], 0
    s_mov_b32 s93, 28672
    v_exp_f32 v96, v96
    v_exp_f32 v97, v97
    v_exp_f32 v98, v98
    v_exp_f32 v99, v99
    v_mfma_f32_32x32x16_bf16 v[112:127], v[244:247], v[60:63], v[112:127]
    v_exp_f32 v100, v100
    v_exp_f32 v101, v101
    v_exp_f32 v102, v102
    v_exp_f32 v103, v103
    v_smfmac_f32_32x32x32_bf16 v[144:159], v[252:255], v[88:95], v22
    buffer_load_dwordx4 v[232:235], v25, s[20:23], s93 offen offset:0 sc1
    v_exp_f32 v104, v104
    v_exp_f32 v105, v105
    v_exp_f32 v106, v106
    v_exp_f32 v107, v107
    v_smfmac_f32_32x32x32_bf16 v[160:175], v[248:251], v[96:103], v22
    s_waitcnt vmcnt(9)
    v_exp_f32 v108, v108
    v_exp_f32 v109, v109
    v_exp_f32 v110, v110
    v_exp_f32 v111, v111
    v_mfma_f32_32x32x16_bf16 v[64:79], v[192:195], v[32:35], 0
    v_exp_f32 v112, v112
    v_exp_f32 v113, v113
    v_exp_f32 v114, v114
    v_exp_f32 v115, v115
    v_mfma_f32_32x32x16_bf16 v[64:79], v[196:199], v[36:39], v[64:79]
    v_exp_f32 v116, v116
    v_exp_f32 v117, v117
    v_exp_f32 v118, v118
    v_exp_f32 v119, v119
    v_smfmac_f32_32x32x32_bf16 v[160:175], v[252:255], v[104:111], v22
    buffer_load_dwordx4 v[236:239], v25, s[20:23], s93 offen offset:1024 sc1
    v_exp_f32 v120, v120
    v_exp_f32 v121, v121
    v_exp_f32 v122, v122
    v_exp_f32 v123, v123
    v_smfmac_f32_32x32x32_bf16 v[176:191], v[248:251], v[112:119], v22
    s_waitcnt vmcnt(8)
    v_exp_f32 v124, v124
    v_exp_f32 v125, v125
    v_exp_f32 v126, v126
    v_exp_f32 v127, v127
    v_mfma_f32_32x32x16_bf16 v[80:95], v[192:195], v[40:43], 0
    s_mov_b32 s92, 1290240
    v_exp_f32 v64, v64
    v_exp_f32 v65, v65
    v_exp_f32 v66, v66
    v_exp_f32 v67, v67
    v_mfma_f32_32x32x16_bf16 v[80:95], v[196:199], v[44:47], v[80:95]
    v_exp_f32 v68, v68
    v_exp_f32 v69, v69
    v_exp_f32 v70, v70
    v_exp_f32 v71, v71
    v_smfmac_f32_32x32x32_bf16 v[176:191], v[252:255], v[120:127], v22
    buffer_load_dwordx4 v[240:243], v26, s[20:23], s92 offen offset:0 sc1
    v_exp_f32 v72, v72
    v_exp_f32 v73, v73
    v_exp_f32 v74, v74
    v_exp_f32 v75, v75
    v_smfmac_f32_32x32x32_bf16 v[128:143], v[200:203], v[64:71], v22
    v_exp_f32 v76, v76
    v_exp_f32 v77, v77
    v_exp_f32 v78, v78
    v_exp_f32 v79, v79
    v_mfma_f32_32x32x16_bf16 v[96:111], v[192:195], v[48:51], 0
    v_exp_f32 v80, v80
    v_exp_f32 v81, v81
    v_exp_f32 v82, v82
    v_exp_f32 v83, v83
    v_mfma_f32_32x32x16_bf16 v[96:111], v[196:199], v[52:55], v[96:111]
    v_exp_f32 v84, v84
    v_exp_f32 v85, v85
    v_exp_f32 v86, v86
    v_exp_f32 v87, v87
    v_smfmac_f32_32x32x32_bf16 v[128:143], v[204:207], v[72:79], v22
    buffer_load_dwordx4 v[244:247], v26, s[20:23], s92 offen offset:1024 sc1
    v_exp_f32 v88, v88
    v_exp_f32 v89, v89
    v_exp_f32 v90, v90
    v_exp_f32 v91, v91
    v_smfmac_f32_32x32x32_bf16 v[144:159], v[200:203], v[80:87], v22
    v_exp_f32 v92, v92
    v_exp_f32 v93, v93
    v_exp_f32 v94, v94
    v_exp_f32 v95, v95
    v_mfma_f32_32x32x16_bf16 v[112:127], v[192:195], v[56:59], 0
    s_mov_b32 s93, 30720
    v_exp_f32 v96, v96
    v_exp_f32 v97, v97
    v_exp_f32 v98, v98
    v_exp_f32 v99, v99
    v_mfma_f32_32x32x16_bf16 v[112:127], v[196:199], v[60:63], v[112:127]
    v_exp_f32 v100, v100
    v_exp_f32 v101, v101
    v_exp_f32 v102, v102
    v_exp_f32 v103, v103
    v_smfmac_f32_32x32x32_bf16 v[144:159], v[204:207], v[88:95], v22
    buffer_load_dwordx4 v[248:251], v25, s[20:23], s93 offen offset:0 sc1
    v_exp_f32 v104, v104
    v_exp_f32 v105, v105
    v_exp_f32 v106, v106
    v_exp_f32 v107, v107
    v_smfmac_f32_32x32x32_bf16 v[160:175], v[200:203], v[96:103], v22
    s_waitcnt vmcnt(9)
    v_exp_f32 v108, v108
    v_exp_f32 v109, v109
    v_exp_f32 v110, v110
    v_exp_f32 v111, v111
    v_mfma_f32_32x32x16_bf16 v[64:79], v[208:211], v[32:35], 0
    v_exp_f32 v112, v112
    v_exp_f32 v113, v113
    v_exp_f32 v114, v114
    v_exp_f32 v115, v115
    v_mfma_f32_32x32x16_bf16 v[64:79], v[212:215], v[36:39], v[64:79]
    v_exp_f32 v116, v116
    v_exp_f32 v117, v117
    v_exp_f32 v118, v118
    v_exp_f32 v119, v119
    v_smfmac_f32_32x32x32_bf16 v[160:175], v[204:207], v[104:111], v22
    buffer_load_dwordx4 v[252:255], v25, s[20:23], s93 offen offset:1024 sc1
    v_exp_f32 v120, v120
    v_exp_f32 v121, v121
    v_exp_f32 v122, v122
    v_exp_f32 v123, v123
    v_smfmac_f32_32x32x32_bf16 v[176:191], v[200:203], v[112:119], v22
    s_waitcnt vmcnt(8)
    v_exp_f32 v124, v124
    v_exp_f32 v125, v125
    v_exp_f32 v126, v126
    v_exp_f32 v127, v127
    v_mfma_f32_32x32x16_bf16 v[80:95], v[208:211], v[40:43], 0
    v_exp_f32 v64, v64
    v_exp_f32 v65, v65
    v_exp_f32 v66, v66
    v_exp_f32 v67, v67
    v_mfma_f32_32x32x16_bf16 v[80:95], v[212:215], v[44:47], v[80:95]
    v_exp_f32 v68, v68
    v_exp_f32 v69, v69
    v_exp_f32 v70, v70
    v_exp_f32 v71, v71
    v_smfmac_f32_32x32x32_bf16 v[176:191], v[204:207], v[120:127], v22
    v_exp_f32 v72, v72
    v_exp_f32 v73, v73
    v_exp_f32 v74, v74
    v_exp_f32 v75, v75
    v_smfmac_f32_32x32x32_bf16 v[128:143], v[216:219], v[64:71], v22
    v_exp_f32 v76, v76
    v_exp_f32 v77, v77
    v_exp_f32 v78, v78
    v_exp_f32 v79, v79
    v_mfma_f32_32x32x16_bf16 v[96:111], v[208:211], v[48:51], 0
    v_exp_f32 v80, v80
    v_exp_f32 v81, v81
    v_exp_f32 v82, v82
    v_exp_f32 v83, v83
    v_mfma_f32_32x32x16_bf16 v[96:111], v[212:215], v[52:55], v[96:111]
    v_exp_f32 v84, v84
    v_exp_f32 v85, v85
    v_exp_f32 v86, v86
    v_exp_f32 v87, v87
    v_smfmac_f32_32x32x32_bf16 v[128:143], v[220:223], v[72:79], v22
    v_exp_f32 v88, v88
    v_exp_f32 v89, v89
    v_exp_f32 v90, v90
    v_exp_f32 v91, v91
    v_smfmac_f32_32x32x32_bf16 v[144:159], v[216:219], v[80:87], v22
    v_exp_f32 v92, v92
    v_exp_f32 v93, v93
    v_exp_f32 v94, v94
    v_exp_f32 v95, v95
    v_mfma_f32_32x32x16_bf16 v[112:127], v[208:211], v[56:59], 0
    v_exp_f32 v96, v96
    v_exp_f32 v97, v97
    v_exp_f32 v98, v98
    v_exp_f32 v99, v99
    v_mfma_f32_32x32x16_bf16 v[112:127], v[212:215], v[60:63], v[112:127]
    v_exp_f32 v100, v100
    v_exp_f32 v101, v101
    v_exp_f32 v102, v102
    v_exp_f32 v103, v103
    v_smfmac_f32_32x32x32_bf16 v[144:159], v[220:223], v[88:95], v22
    v_exp_f32 v104, v104
    v_exp_f32 v105, v105
    v_exp_f32 v106, v106
    v_exp_f32 v107, v107
    v_smfmac_f32_32x32x32_bf16 v[160:175], v[216:219], v[96:103], v22
    s_waitcnt vmcnt(6)
    v_exp_f32 v108, v108
    v_exp_f32 v109, v109
    v_exp_f32 v110, v110
    v_exp_f32 v111, v111
    v_mfma_f32_32x32x16_bf16 v[64:79], v[224:227], v[32:35], 0
    v_exp_f32 v112, v112
    v_exp_f32 v113, v113
    v_exp_f32 v114, v114
    v_exp_f32 v115, v115
    v_mfma_f32_32x32x16_bf16 v[64:79], v[228:231], v[36:39], v[64:79]
    v_exp_f32 v116, v116
    v_exp_f32 v117, v117
    v_exp_f32 v118, v118
    v_exp_f32 v119, v119
    v_smfmac_f32_32x32x32_bf16 v[160:175], v[220:223], v[104:111], v22
    v_exp_f32 v120, v120
    v_exp_f32 v121, v121
    v_exp_f32 v122, v122
    v_exp_f32 v123, v123
    v_smfmac_f32_32x32x32_bf16 v[176:191], v[216:219], v[112:119], v22
    s_waitcnt vmcnt(4)
    v_exp_f32 v124, v124
    v_exp_f32 v125, v125
    v_exp_f32 v126, v126
    v_exp_f32 v127, v127
    v_mfma_f32_32x32x16_bf16 v[80:95], v[224:227], v[40:43], 0
    v_exp_f32 v64, v64
    v_exp_f32 v65, v65
    v_exp_f32 v66, v66
    v_exp_f32 v67, v67
    v_mfma_f32_32x32x16_bf16 v[80:95], v[228:231], v[44:47], v[80:95]
    v_exp_f32 v68, v68
    v_exp_f32 v69, v69
    v_exp_f32 v70, v70
    v_exp_f32 v71, v71
    v_smfmac_f32_32x32x32_bf16 v[176:191], v[220:223], v[120:127], v22
    v_exp_f32 v72, v72
    v_exp_f32 v73, v73
    v_exp_f32 v74, v74
    v_exp_f32 v75, v75
    v_smfmac_f32_32x32x32_bf16 v[128:143], v[232:235], v[64:71], v22
    v_exp_f32 v76, v76
    v_exp_f32 v77, v77
    v_exp_f32 v78, v78
    v_exp_f32 v79, v79
    v_mfma_f32_32x32x16_bf16 v[96:111], v[224:227], v[48:51], 0
    v_exp_f32 v80, v80
    v_exp_f32 v81, v81
    v_exp_f32 v82, v82
    v_exp_f32 v83, v83
    v_mfma_f32_32x32x16_bf16 v[96:111], v[228:231], v[52:55], v[96:111]
    v_exp_f32 v84, v84
    v_exp_f32 v85, v85
    v_exp_f32 v86, v86
    v_exp_f32 v87, v87
    v_smfmac_f32_32x32x32_bf16 v[128:143], v[236:239], v[72:79], v22
    v_exp_f32 v88, v88
    v_exp_f32 v89, v89
    v_exp_f32 v90, v90
    v_exp_f32 v91, v91
    v_smfmac_f32_32x32x32_bf16 v[144:159], v[232:235], v[80:87], v22
    v_exp_f32 v92, v92
    v_exp_f32 v93, v93
    v_exp_f32 v94, v94
    v_exp_f32 v95, v95
    v_mfma_f32_32x32x16_bf16 v[112:127], v[224:227], v[56:59], 0
    v_exp_f32 v96, v96
    v_exp_f32 v97, v97
    v_exp_f32 v98, v98
    v_exp_f32 v99, v99
    v_mfma_f32_32x32x16_bf16 v[112:127], v[228:231], v[60:63], v[112:127]
    v_exp_f32 v100, v100
    v_exp_f32 v101, v101
    v_exp_f32 v102, v102
    v_exp_f32 v103, v103
    v_smfmac_f32_32x32x32_bf16 v[144:159], v[236:239], v[88:95], v22
    v_exp_f32 v104, v104
    v_exp_f32 v105, v105
    v_exp_f32 v106, v106
    v_exp_f32 v107, v107
    v_smfmac_f32_32x32x32_bf16 v[160:175], v[232:235], v[96:103], v22
    s_waitcnt vmcnt(2)
    v_exp_f32 v108, v108
    v_exp_f32 v109, v109
    v_exp_f32 v110, v110
    v_exp_f32 v111, v111
    v_mfma_f32_32x32x16_bf16 v[64:79], v[240:243], v[32:35], 0
    v_exp_f32 v112, v112
    v_exp_f32 v113, v113
    v_exp_f32 v114, v114
    v_exp_f32 v115, v115
    v_mfma_f32_32x32x16_bf16 v[64:79], v[244:247], v[36:39], v[64:79]
    v_exp_f32 v116, v116
    v_exp_f32 v117, v117
    v_exp_f32 v118, v118
    v_exp_f32 v119, v119
    v_smfmac_f32_32x32x32_bf16 v[160:175], v[236:239], v[104:111], v22
    v_exp_f32 v120, v120
    v_exp_f32 v121, v121
    v_exp_f32 v122, v122
    v_exp_f32 v123, v123
    v_smfmac_f32_32x32x32_bf16 v[176:191], v[232:235], v[112:119], v22
    s_waitcnt vmcnt(0)
    v_exp_f32 v124, v124
    v_exp_f32 v125, v125
    v_exp_f32 v126, v126
    v_exp_f32 v127, v127
    v_mfma_f32_32x32x16_bf16 v[80:95], v[240:243], v[40:43], 0
    v_exp_f32 v64, v64
    v_exp_f32 v65, v65
    v_exp_f32 v66, v66
    v_exp_f32 v67, v67
    v_mfma_f32_32x32x16_bf16 v[80:95], v[244:247], v[44:47], v[80:95]
    v_exp_f32 v68, v68
    v_exp_f32 v69, v69
    v_exp_f32 v70, v70
    v_exp_f32 v71, v71
    v_smfmac_f32_32x32x32_bf16 v[176:191], v[236:239], v[120:127], v22
    v_exp_f32 v72, v72
    v_exp_f32 v73, v73
    v_exp_f32 v74, v74
    v_exp_f32 v75, v75
    v_smfmac_f32_32x32x32_bf16 v[128:143], v[248:251], v[64:71], v22
    v_exp_f32 v76, v76
    v_exp_f32 v77, v77
    v_exp_f32 v78, v78
    v_exp_f32 v79, v79
    v_mfma_f32_32x32x16_bf16 v[96:111], v[240:243], v[48:51], 0
    v_exp_f32 v80, v80
    v_exp_f32 v81, v81
    v_exp_f32 v82, v82
    v_exp_f32 v83, v83
    v_mfma_f32_32x32x16_bf16 v[96:111], v[244:247], v[52:55], v[96:111]
    v_exp_f32 v84, v84
    v_exp_f32 v85, v85
    v_exp_f32 v86, v86
    v_exp_f32 v87, v87
    v_smfmac_f32_32x32x32_bf16 v[128:143], v[252:255], v[72:79], v22
    v_exp_f32 v88, v88
    v_exp_f32 v89, v89
    v_exp_f32 v90, v90
    v_exp_f32 v91, v91
    v_smfmac_f32_32x32x32_bf16 v[144:159], v[248:251], v[80:87], v22
    v_exp_f32 v92, v92
    v_exp_f32 v93, v93
    v_exp_f32 v94, v94
    v_exp_f32 v95, v95
    v_mfma_f32_32x32x16_bf16 v[112:127], v[240:243], v[56:59], 0
    v_exp_f32 v96, v96
    v_exp_f32 v97, v97
    v_exp_f32 v98, v98
    v_exp_f32 v99, v99
    v_mfma_f32_32x32x16_bf16 v[112:127], v[244:247], v[60:63], v[112:127]
    v_exp_f32 v100, v100
    v_exp_f32 v101, v101
    v_exp_f32 v102, v102
    v_exp_f32 v103, v103
    v_smfmac_f32_32x32x32_bf16 v[144:159], v[252:255], v[88:95], v22
    ds_write_b128 v12, v[128:131] offset:0
    ds_write_b128 v12, v[132:135] offset:1024
    v_exp_f32 v104, v104
    v_exp_f32 v105, v105
    v_exp_f32 v106, v106
    v_exp_f32 v107, v107
    v_smfmac_f32_32x32x32_bf16 v[160:175], v[248:251], v[96:103], v22
    ds_write_b128 v12, v[136:139] offset:2048
    ds_write_b128 v12, v[140:143] offset:3072
    v_exp_f32 v108, v108
    v_exp_f32 v109, v109
    v_exp_f32 v110, v110
    v_exp_f32 v111, v111
    v_exp_f32 v112, v112
    v_exp_f32 v113, v113
    v_exp_f32 v114, v114
    v_exp_f32 v115, v115
    v_exp_f32 v116, v116
    v_exp_f32 v117, v117
    v_exp_f32 v118, v118
    v_exp_f32 v119, v119
    v_smfmac_f32_32x32x32_bf16 v[160:175], v[252:255], v[104:111], v22
    ds_write_b128 v13, v[144:147] offset:0
    ds_write_b128 v13, v[148:151] offset:1024
    v_exp_f32 v120, v120
    v_exp_f32 v121, v121
    v_exp_f32 v122, v122
    v_exp_f32 v123, v123
    v_smfmac_f32_32x32x32_bf16 v[176:191], v[248:251], v[112:119], v22
    ds_write_b128 v13, v[152:155] offset:2048
    ds_write_b128 v13, v[156:159] offset:3072
    v_exp_f32 v124, v124
    v_exp_f32 v125, v125
    v_exp_f32 v126, v126
    v_exp_f32 v127, v127
    s_nop 1
    v_smfmac_f32_32x32x32_bf16 v[176:191], v[252:255], v[120:127], v22
    s_branch L_red2
L_reduce:
    ds_write_b128 v12, v[128:131] offset:0
    ds_write_b128 v12, v[132:135] offset:1024
    ds_write_b128 v12, v[136:139] offset:2048
    ds_write_b128 v12, v[140:143] offset:3072
    ds_write_b128 v13, v[144:147] offset:0
    ds_write_b128 v13, v[148:151] offset:1024
    ds_write_b128 v13, v[152:155] offset:2048
    ds_write_b128 v13, v[156:159] offset:3072
L_red2:
    ds_write_b128 v14, v[160:163] offset:0
    ds_write_b128 v14, v[164:167] offset:1024
    ds_write_b128 v14, v[168:171] offset:2048
    ds_write_b128 v14, v[172:175] offset:3072
    s_mov_b64 exec, 1
    ds_add_u32 v17, v16 offset:40
    s_mov_b64 exec, -1
L_spin_37:
    ds_read_b32 v2, v17 offset:40
    s_waitcnt lgkmcnt(0)
    v_readfirstlane_b32 s83, v2
    s_cmp_ge_u32 s83, s77
    s_cbranch_scc1 L_spun_38
    s_sub_u32 s79, s79, 1
    s_cbranch_scc0 L_spin_37
    s_mov_b32 s79, 0
L_spun_38:
    ds_read_b128 v[64:67], v15 offset:0
    ds_read_b128 v[68:71], v15 offset:4096
    ds_read_b128 v[72:75], v15 offset:8192
    ds_read_b128 v[76:79], v15 offset:1024
    ds_read_b128 v[80:83], v15 offset:5120
    ds_read_b128 v[84:87], v15 offset:9216
    ds_read_b128 v[88:91], v15 offset:2048
    ds_read_b128 v[92:95], v15 offset:6144
    ds_read_b128 v[96:99], v15 offset:10240
    ds_read_b128 v[100:103], v15 offset:3072
    ds_read_b128 v[104:107], v15 offset:7168
    ds_read_b128 v[108:111], v15 offset:11264
    s_waitcnt lgkmcnt(9)
    v_pk_add_f32 v[176:177], v[176:177], v[64:65]
    v_pk_add_f32 v[178:179], v[178:179], v[66:67]
    v_pk_add_f32 v[176:177], v[176:177], v[68:69]
    v_pk_add_f32 v[178:179], v[178:179], v[70:71]
    v_pk_add_f32 v[176:177], v[176:177], v[72:73]
    v_pk_add_f32 v[178:179], v[178:179], v[74:75]
    s_waitcnt lgkmcnt(6)
    v_pk_add_f32 v[180:181], v[180:181], v[76:77]
    v_pk_add_f32 v[182:183], v[182:183], v[78:79]
    v_pk_add_f32 v[180:181], v[180:181], v[80:81]
    v_pk_add_f32 v[182:183], v[182:183], v[82:83]
    v_pk_add_f32 v[180:181], v[180:181], v[84:85]
    v_pk_add_f32 v[182:183], v[182:183], v[86:87]
    s_waitcnt lgkmcnt(3)
    v_pk_add_f32 v[184:185], v[184:185], v[88:89]
    v_pk_add_f32 v[186:187], v[186:187], v[90:91]
    v_pk_add_f32 v[184:185], v[184:185], v[92:93]
    v_pk_add_f32 v[186:187], v[186:187], v[94:95]
    v_pk_add_f32 v[184:185], v[184:185], v[96:97]
    v_pk_add_f32 v[186:187], v[186:187], v[98:99]
    s_waitcnt lgkmcnt(0)
    v_pk_add_f32 v[188:189], v[188:189], v[100:101]
    v_pk_add_f32 v[190:191], v[190:191], v[102:103]
    v_pk_add_f32 v[188:189], v[188:189], v[104:105]
    v_pk_add_f32 v[190:191], v[190:191], v[106:107]
    v_pk_add_f32 v[188:189], v[188:189], v[108:109]
    v_pk_add_f32 v[190:191], v[190:191], v[110:111]
    v_mov_b32 v5, v188
    v_mov_b32 v4, v188
    s_nop 1
    v_permlane32_swap_b32 v5, v4
    v_rcp_f32 v6, v4
    v_mov_b32 v8, 0
    v_mov_b32 v9, 0
    v_mul_f32 v6, v6, v23
    v_mov_b32 v7, v6
    v_pk_fma_f32 v[8:9], v[176:177], 0, v[8:9] op_sel_hi:[1,0,1]
    v_pk_mul_f32 v[64:65], v[176:177], v[6:7]
    v_pk_fma_f32 v[8:9], v[178:179], 0, v[8:9] op_sel_hi:[1,0,1]
    v_pk_mul_f32 v[66:67], v[178:179], v[6:7]
    v_pk_fma_f32 v[8:9], v[180:181], 0, v[8:9] op_sel_hi:[1,0,1]
    v_pk_mul_f32 v[68:69], v[180:181], v[6:7]
    v_pk_fma_f32 v[8:9], v[182:183], 0, v[8:9] op_sel_hi:[1,0,1]
    v_pk_mul_f32 v[70:71], v[182:183], v[6:7]
    v_pk_fma_f32 v[8:9], v[184:185], 0, v[8:9] op_sel_hi:[1,0,1]
    v_pk_mul_f32 v[72:73], v[184:185], v[6:7]
    v_pk_fma_f32 v[8:9], v[186:187], 0, v[8:9] op_sel_hi:[1,0,1]
    v_pk_mul_f32 v[74:75], v[186:187], v[6:7]
    v_pk_fma_f32 v[8:9], v[188:189], 0, v[8:9] op_sel_hi:[1,0,1]
    v_pk_mul_f32 v[76:77], v[188:189], v[6:7]
    v_pk_fma_f32 v[8:9], v[190:191], 0, v[8:9] op_sel_hi:[1,0,1]
    v_pk_mul_f32 v[78:79], v[190:191], v[6:7]
    v_add_f32 v8, v8, v9
    v_add_f32 v4, v4, v8
    v_cmp_nle_f32 vcc, 0x1f800000, v4
    s_mov_b64 s[94:95], vcc
    v_cmp_nge_f32 vcc, 0x5f800000, v4
    v_cvt_pk_bf16_f32 v80, v64, v65
    v_cvt_pk_bf16_f32 v81, v66, v67
    v_cvt_pk_bf16_f32 v82, v68, v69
    v_cvt_pk_bf16_f32 v83, v70, v71
    v_cvt_pk_bf16_f32 v84, v72, v73
    v_cvt_pk_bf16_f32 v85, v74, v75
    v_cvt_pk_bf16_f32 v86, v76, v77
    v_cvt_pk_bf16_f32 v87, v78, v79
    v_min_u32 v80, -2, v80
    v_min_u32 v84, -2, v84
    s_or_b64 vcc, vcc, s[94:95]
    s_cmp_lg_u64 vcc, 0
    s_cselect_b32 s74, 0x101, 1
    s_andn2_b32 s74, s74, s80
    s_lshr_b32 s75, s74, 8
    s_or_b32 s75, s75, s38
    s_cmp_lg_u32 s75, 0
    v_mov_b32 v3, s74
    s_cbranch_scc1 L_nostore
    v_cndmask_b32 v86, v86, v27, s[0:1]
    buffer_store_dwordx4 v[80:83], v19, s[20:23], 0 offen offset:0 sc1
    buffer_store_dwordx4 v[84:87], v19, s[20:23], 0 offen offset:1024 sc1
    buffer_store_dword v30, v11, s[20:23], 0 offen sc1
    s_mov_b32 s38, 1
L_nostore:
    s_mov_b64 exec, 1
    ds_add_u32 v17, v3 offset:44
    s_mov_b64 exec, -1
    s_cmp_lg_u32 s80, 0
    s_cbranch_scc1 L_mdone
L_spin_39:
    ds_read_b32 v2, v17 offset:44
    s_waitcnt lgkmcnt(0)
    v_readfirstlane_b32 s83, v2
    s_and_b32 s94, s83, 255
    s_cmp_ge_u32 s94, 4
    s_cbranch_scc1 L_spun_40
    s_sub_u32 s79, s79, 1
    s_cbranch_scc0 L_spin_39
    s_mov_b32 s79, 0
L_spun_40:
    s_lshr_b32 s73, s83, 8
    s_cmp_lg_u32 s73, 0
    s_cbranch_scc1 L_fallback
L_mdone:
    s_mov_b64 exec, 1
    ds_add_u32 v17, v16 offset:20
    s_mov_b64 exec, -1
L_fin:
L_end:
    s_endpgm
L_fallback:
    s_mov_b32 s80, 0x100
    s_mov_b32 s77, 12
    s_waitcnt vmcnt(0)
    v_mov_b32 v7, 0xff800000
    v_mov_b32 v8, 0xff800000
    v_mov_b32 v9, 0xff800000
    v_mov_b32 v10, 0xff800000
    s_mov_b32 s92, 0
L_fb1:
    buffer_load_dwordx4 v[192:195], v26, s[20:23], s92 offen offset:0 sc1
    buffer_load_dwordx4 v[196:199], v26, s[20:23], s92 offen offset:1024 sc1
    s_waitcnt vmcnt(0)
    v_mfma_f32_32x32x16_bf16 v[64:79], v[192:195], v[32:35], 0
    v_mfma_f32_32x32x16_bf16 v[64:79], v[196:199], v[36:39], v[64:79]
    v_mfma_f32_32x32x16_bf16 v[80:95], v[192:195], v[40:43], 0
    v_mfma_f32_32x32x16_bf16 v[80:95], v[196:199], v[44:47], v[80:95]
    v_mfma_f32_32x32x16_bf16 v[96:111], v[192:195], v[48:51], 0
    v_mfma_f32_32x32x16_bf16 v[96:111], v[196:199], v[52:55], v[96:111]
    v_mfma_f32_32x32x16_bf16 v[112:127], v[192:195], v[56:59], 0
    v_mfma_f32_32x32x16_bf16 v[112:127], v[196:199], v[60:63], v[112:127]
    s_nop 11
    v_max3_f32 v7, v64, v65, v7
    v_max3_f32 v7, v66, v67, v7
    v_max3_f32 v7, v68, v69, v7
    v_max3_f32 v7, v70, v71, v7
    v_max3_f32 v7, v72, v73, v7
    v_max3_f32 v7, v74, v75, v7
    v_max3_f32 v7, v76, v77, v7
    v_max3_f32 v7, v78, v79, v7
    v_max3_f32 v8, v80, v81, v8
    v_max3_f32 v8, v82, v83, v8
    v_max3_f32 v8, v84, v85, v8
    v_max3_f32 v8, v86, v87, v8
    v_max3_f32 v8, v88, v89, v8
    v_max3_f32 v8, v90, v91, v8
    v_max3_f32 v8, v92, v93, v8
    v_max3_f32 v8, v94, v95, v8
    v_max3_f32 v9, v96, v97, v9
    v_max3_f32 v9, v98, v99, v9
    v_max3_f32 v9, v100, v101, v9
    v_max3_f32 v9, v102, v103, v9
    v_max3_f32 v9, v104, v105, v9
    v_max3_f32 v9, v106, v107, v9
    v_max3_f32 v9, v108, v109, v9
    v_max3_f32 v9, v110, v111, v9
    v_max3_f32 v10, v112, v113, v10
    v_max3_f32 v10, v114, v115, v10
    v_max3_f32 v10, v116, v117, v10
    v_max3_f32 v10, v118, v119, v10
    v_max3_f32 v10, v120, v121, v10
    v_max3_f32 v10, v122, v123, v10
    v_max3_f32 v10, v124, v125, v10
    v_max3_f32 v10, v126, v127, v10
    s_add_u32 s92, s92, 86016
    s_cmp_lt_u32 s92, 1376256
    s_cbranch_scc1 L_fb1
    v_mov_b32 v2, v7
    v_mov_b32 v3, v7
    s_nop 1
    v_permlane32_swap_b32 v2, v3
    v_max_f32 v2, v2, v3
    s_add_u32 s73, s3, 1
    s_and_b32 s73, s73, 3
    s_lshl_b32 s73, s73, 10
    s_add_u32 s73, s73, 106496
    v_lshlrev_b32 v4, 2, v1
    v_add_u32 v64, s73, v4
    s_lshl_b32 s73, s3, 8
    v_add_u32 v4, s73, v64
    ds_write_b32 v4, v2
    v_mov_b32 v2, v8
    v_mov_b32 v3, v8
    s_nop 1
    v_permlane32_swap_b32 v2, v3
    v_max_f32 v2, v2, v3
    s_add_u32 s73, s3, 2
    s_and_b32 s73, s73, 3
    s_lshl_b32 s73, s73, 10
    s_add_u32 s73, s73, 106496
    v_lshlrev_b32 v4, 2, v1
    v_add_u32 v65, s73, v4
    s_lshl_b32 s73, s3, 8
    v_add_u32 v4, s73, v65
    ds_write_b32 v4, v2
    v_mov_b32 v2, v9
    v_mov_b32 v3, v9
    s_nop 1
    v_permlane32_swap_b32 v2, v3
    v_max_f32 v2, v2, v3
    s_add_u32 s73, s3, 3
    s_and_b32 s73, s73, 3
    s_lshl_b32 s73, s73, 10
    s_add_u32 s73, s73, 106496
    v_lshlrev_b32 v4, 2, v1
    v_add_u32 v66, s73, v4
    s_lshl_b32 s73, s3, 8
    v_add_u32 v4, s73, v66
    ds_write_b32 v4, v2
    v_mov_b32 v2, v10
    v_mov_b32 v3, v10
    s_nop 1
    v_permlane32_swap_b32 v2, v3
    v_max_f32 v2, v2, v3
    s_add_u32 s73, s3, 4
    s_and_b32 s73, s73, 3
    s_lshl_b32 s73, s73, 10
    s_add_u32 s73, s73, 106496
    v_lshlrev_b32 v4, 2, v1
    v_add_u32 v67, s73, v4
    s_lshl_b32 s73, s3, 8
    v_add_u32 v4, s73, v67
    ds_write_b32 v4, v2
    s_mov_b64 exec, 1
    ds_add_u32 v17, v16 offset:48
    s_mov_b64 exec, -1
L_spin_41:
    ds_read_b32 v2, v17 offset:48
    s_waitcnt lgkmcnt(0)
    v_readfirstlane_b32 s83, v2
    s_cmp_ge_u32 s83, 4
    s_cbranch_scc1 L_spun_42
    s_sleep 1
    s_sub_u32 s79, s79, 1
    s_cbranch_scc0 L_spin_41
    s_mov_b32 s79, 0
L_spun_42:
    ds_read_b32 v2, v64 offset:0
    ds_read_b32 v3, v64 offset:256
    ds_read_b32 v4, v64 offset:512
    ds_read_b32 v5, v64 offset:768
    s_waitcnt lgkmcnt(0)
    v_max3_f32 v2, v2, v3, v4
    v_max_f32 v7, v2, v5
    ds_read_b32 v2, v65 offset:0
    ds_read_b32 v3, v65 offset:256
    ds_read_b32 v4, v65 offset:512
    ds_read_b32 v5, v65 offset:768
    s_waitcnt lgkmcnt(0)
    v_max3_f32 v2, v2, v3, v4
    v_max_f32 v8, v2, v5
    ds_read_b32 v2, v66 offset:0
    ds_read_b32 v3, v66 offset:256
    ds_read_b32 v4, v66 offset:512
    ds_read_b32 v5, v66 offset:768
    s_waitcnt lgkmcnt(0)
    v_max3_f32 v2, v2, v3, v4
    v_max_f32 v9, v2, v5
    ds_read_b32 v2, v67 offset:0
    ds_read_b32 v3, v67 offset:256
    ds_read_b32 v4, v67 offset:512
    ds_read_b32 v5, v67 offset:768
    s_waitcnt lgkmcnt(0)
    v_max3_f32 v2, v2, v3, v4
    v_max_f32 v10, v2, v5
    s_mov_b64 exec, 1
    ds_add_u32 v17, v16 offset:52
    s_mov_b64 exec, -1
L_spin_43:
    ds_read_b32 v2, v17 offset:52
    s_waitcnt lgkmcnt(0)
    v_readfirstlane_b32 s83, v2
    s_cmp_ge_u32 s83, 4
    s_cbranch_scc1 L_spun_44
    s_sleep 1
    s_sub_u32 s79, s79, 1
    s_cbranch_scc0 L_spin_43
    s_mov_b32 s79, 0
L_spun_44:
    v_mov_b32 v128, 0
    v_mov_b32 v129, 0
    v_mov_b32 v130, 0
    v_mov_b32 v131, 0
    v_mov_b32 v132, 0
    v_mov_b32 v133, 0
    v_mov_b32 v134, 0
    v_mov_b32 v135, 0
    v_mov_b32 v136, 0
    v_mov_b32 v137, 0
    v_mov_b32 v138, 0
    v_mov_b32 v139, 0
    v_mov_b32 v140, 0
    v_mov_b32 v141, 0
    v_mov_b32 v142, 0
    v_mov_b32 v143, 0
    v_mov_b32 v144, 0
    v_mov_b32 v145, 0
    v_mov_b32 v146, 0
    v_mov_b32 v147, 0
    v_mov_b32 v148, 0
    v_mov_b32 v149, 0
    v_mov_b32 v150, 0
    v_mov_b32 v151, 0
    v_mov_b32 v152, 0
    v_mov_b32 v153, 0
    v_mov_b32 v154, 0
    v_mov_b32 v155, 0
    v_mov_b32 v156, 0
    v_mov_b32 v157, 0
    v_mov_b32 v158, 0
    v_mov_b32 v159, 0
    v_mov_b32 v160, 0
    v_mov_b32 v161, 0
    v_mov_b32 v162, 0
    v_mov_b32 v163, 0
    v_mov_b32 v164, 0
    v_mov_b32 v165, 0
    v_mov_b32 v166, 0
    v_mov_b32 v167, 0
    v_mov_b32 v168, 0
    v_mov_b32 v169, 0
    v_mov_b32 v170, 0
    v_mov_b32 v171, 0
    v_mov_b32 v172, 0
    v_mov_b32 v173, 0
    v_mov_b32 v174, 0
    v_mov_b32 v175, 0
    v_mov_b32 v176, 0
    v_mov_b32 v177, 0
    v_mov_b32 v178, 0
    v_mov_b32 v179, 0
    v_mov_b32 v180, 0
    v_mov_b32 v181, 0
    v_mov_b32 v182, 0
    v_mov_b32 v183, 0
    v_mov_b32 v184, 0
    v_mov_b32 v185, 0
    v_mov_b32 v186, 0
    v_mov_b32 v187, 0
    v_mov_b32 v188, 0
    v_mov_b32 v189, 0
    v_mov_b32 v190, 0
    v_mov_b32 v191, 0
    s_mov_b32 s92, 0
    s_mov_b32 s93, 0
    v_mov_b32 v208, v7
    v_mov_b32 v209, v8
    v_mov_b32 v210, v9
    v_mov_b32 v211, v10
L_fb2:
    buffer_load_dwordx4 v[192:195], v26, s[20:23], s92 offen offset:0 sc1
    buffer_load_dwordx4 v[196:199], v26, s[20:23], s92 offen offset:1024 sc1
    buffer_load_dwordx4 v[200:203], v25, s[20:23], s93 offen offset:0 sc1
    buffer_load_dwordx4 v[204:207], v25, s[20:23], s93 offen offset:1024 sc1
    s_waitcnt vmcnt(0)
    v_mfma_f32_32x32x16_bf16 v[64:79], v[192:195], v[32:35], 0
    v_mfma_f32_32x32x16_bf16 v[64:79], v[196:199], v[36:39], v[64:79]
    v_mfma_f32_32x32x16_bf16 v[80:95], v[192:195], v[40:43], 0
    v_mfma_f32_32x32x16_bf16 v[80:95], v[196:199], v[44:47], v[80:95]
    v_mfma_f32_32x32x16_bf16 v[96:111], v[192:195], v[48:51], 0
    v_mfma_f32_32x32x16_bf16 v[96:111], v[196:199], v[52:55], v[96:111]
    v_mfma_f32_32x32x16_bf16 v[112:127], v[192:195], v[56:59], 0
    v_mfma_f32_32x32x16_bf16 v[112:127], v[196:199], v[60:63], v[112:127]
    s_nop 11
    v_sub_f32 v64, v64, v208
    v_sub_f32 v65, v65, v208
    v_sub_f32 v66, v66, v208
    v_sub_f32 v67, v67, v208
    v_sub_f32 v68, v68, v208
    v_sub_f32 v69, v69, v208
    v_sub_f32 v70, v70, v208
    v_sub_f32 v71, v71, v208
    v_sub_f32 v72, v72, v208
    v_sub_f32 v73, v73, v208
    v_sub_f32 v74, v74, v208
    v_sub_f32 v75, v75, v208
    v_sub_f32 v76, v76, v208
    v_sub_f32 v77, v77, v208
    v_sub_f32 v78, v78, v208
    v_sub_f32 v79, v79, v208
    v_exp_f32 v64, v64
    v_exp_f32 v65, v65
    v_exp_f32 v66, v66
    v_exp_f32 v67, v67
    v_exp_f32 v68, v68
    v_exp_f32 v69, v69
    v_exp_f32 v70, v70
    v_exp_f32 v71, v71
    v_exp_f32 v72, v72
    v_exp_f32 v73, v73
    v_exp_f32 v74, v74
    v_exp_f32 v75, v75
    v_exp_f32 v76, v76
    v_exp_f32 v77, v77
    v_exp_f32 v78, v78
    v_exp_f32 v79, v79
    v_sub_f32 v80, v80, v209
    v_sub_f32 v81, v81, v209
    v_sub_f32 v82, v82, v209
    v_sub_f32 v83, v83, v209
    v_sub_f32 v84, v84, v209
    v_sub_f32 v85, v85, v209
    v_sub_f32 v86, v86, v209
    v_sub_f32 v87, v87, v209
    v_sub_f32 v88, v88, v209
    v_sub_f32 v89, v89, v209
    v_sub_f32 v90, v90, v209
    v_sub_f32 v91, v91, v209
    v_sub_f32 v92, v92, v209
    v_sub_f32 v93, v93, v209
    v_sub_f32 v94, v94, v209
    v_sub_f32 v95, v95, v209
    v_exp_f32 v80, v80
    v_exp_f32 v81, v81
    v_exp_f32 v82, v82
    v_exp_f32 v83, v83
    v_exp_f32 v84, v84
    v_exp_f32 v85, v85
    v_exp_f32 v86, v86
    v_exp_f32 v87, v87
    v_exp_f32 v88, v88
    v_exp_f32 v89, v89
    v_exp_f32 v90, v90
    v_exp_f32 v91, v91
    v_exp_f32 v92, v92
    v_exp_f32 v93, v93
    v_exp_f32 v94, v94
    v_exp_f32 v95, v95
    v_sub_f32 v96, v96, v210
    v_sub_f32 v97, v97, v210
    v_sub_f32 v98, v98, v210
    v_sub_f32 v99, v99, v210
    v_sub_f32 v100, v100, v210
    v_sub_f32 v101, v101, v210
    v_sub_f32 v102, v102, v210
    v_sub_f32 v103, v103, v210
    v_sub_f32 v104, v104, v210
    v_sub_f32 v105, v105, v210
    v_sub_f32 v106, v106, v210
    v_sub_f32 v107, v107, v210
    v_sub_f32 v108, v108, v210
    v_sub_f32 v109, v109, v210
    v_sub_f32 v110, v110, v210
    v_sub_f32 v111, v111, v210
    v_exp_f32 v96, v96
    v_exp_f32 v97, v97
    v_exp_f32 v98, v98
    v_exp_f32 v99, v99
    v_exp_f32 v100, v100
    v_exp_f32 v101, v101
    v_exp_f32 v102, v102
    v_exp_f32 v103, v103
    v_exp_f32 v104, v104
    v_exp_f32 v105, v105
    v_exp_f32 v106, v106
    v_exp_f32 v107, v107
    v_exp_f32 v108, v108
    v_exp_f32 v109, v109
    v_exp_f32 v110, v110
    v_exp_f32 v111, v111
    v_sub_f32 v112, v112, v211
    v_sub_f32 v113, v113, v211
    v_sub_f32 v114, v114, v211
    v_sub_f32 v115, v115, v211
    v_sub_f32 v116, v116, v211
    v_sub_f32 v117, v117, v211
    v_sub_f32 v118, v118, v211
    v_sub_f32 v119, v119, v211
    v_sub_f32 v120, v120, v211
    v_sub_f32 v121, v121, v211
    v_sub_f32 v122, v122, v211
    v_sub_f32 v123, v123, v211
    v_sub_f32 v124, v124, v211
    v_sub_f32 v125, v125, v211
    v_sub_f32 v126, v126, v211
    v_sub_f32 v127, v127, v211
    v_exp_f32 v112, v112
    v_exp_f32 v113, v113
    v_exp_f32 v114, v114
    v_exp_f32 v115, v115
    v_exp_f32 v116, v116
    v_exp_f32 v117, v117
    v_exp_f32 v118, v118
    v_exp_f32 v119, v119
    v_exp_f32 v120, v120
    v_exp_f32 v121, v121
    v_exp_f32 v122, v122
    v_exp_f32 v123, v123
    v_exp_f32 v124, v124
    v_exp_f32 v125, v125
    v_exp_f32 v126, v126
    v_exp_f32 v127, v127
    s_nop 1
    v_smfmac_f32_32x32x32_bf16 v[128:143], v[200:203], v[64:71], v22
    v_smfmac_f32_32x32x32_bf16 v[128:143], v[204:207], v[72:79], v22
    v_smfmac_f32_32x32x32_bf16 v[144:159], v[200:203], v[80:87], v22
    v_smfmac_f32_32x32x32_bf16 v[144:159], v[204:207], v[88:95], v22
    v_smfmac_f32_32x32x32_bf16 v[160:175], v[200:203], v[96:103], v22
    v_smfmac_f32_32x32x32_bf16 v[160:175], v[204:207], v[104:111], v22
    v_smfmac_f32_32x32x32_bf16 v[176:191], v[200:203], v[112:119], v22
    v_smfmac_f32_32x32x32_bf16 v[176:191], v[204:207], v[120:127], v22
    s_nop 11
    s_add_u32 s92, s92, 86016
    s_add_u32 s93, s93, 2048
    s_cmp_lt_u32 s93, 32768
    s_cbranch_scc1 L_fb2
    s_branch L_reduce
L_codeend:
.section .rodata,"a"
.p2align 6
.amdhsa_kernel gated_mix__mha_block__linear_attn_block__prompt_kernel
  .amdhsa_next_free_vgpr 256
  .amdhsa_next_free_sgpr 102
  .amdhsa_accum_offset 256
  .amdhsa_group_segment_fixed_size 0
  .amdhsa_kernarg_size 80
  .amdhsa_user_sgpr_count 2
  .amdhsa_user_sgpr_kernarg_segment_ptr 1
  .amdhsa_system_sgpr_workgroup_id_x 1
.end_amdhsa_kernel
```
